```python
import torch

def _softmax(x, axis=-1):
    return torch.softmax(x, dim=axis)
def _gelu(x):
    return torch.nn.functional.gelu(x, approximate="tanh")
def _silu(x):
    return torch.nn.functional.silu(x)
def _sigmoid(x):
    return torch.sigmoid(x)
def _layernorm(x, axis=-1, eps=1e-5):
    m = x.mean(dim=axis, keepdim=True)
    v = x.var(dim=axis, keepdim=True, unbiased=False)
    return (x - m) / torch.sqrt(v + eps)
def _scatter_add(tgt, idx, src, axis=0):
    return tgt.clone().index_add_(axis, idx, src)
def _segment_sum(src, seg, n):
    out = torch.zeros((n,) + src.shape[1:], dtype=src.dtype)
    return out.index_add_(0, seg, src)
def _pad(x, pw):
    flat = tuple(v for pair in reversed(pw) for v in pair)
    return torch.nn.functional.pad(x, flat)

kernel_name = 'gated_mix__gqa_block_cached__dense_activation_gelu__decode'

def setup_inputs():

    _w = (lambda a: (lambda t: t.to(torch.bfloat16) if t.is_floating_point() else t)(torch.as_tensor(a)))
    def _A_setup():
        B, Sq, D = 1, 1, 448
        Hq, Hkv, Sk, Dh = 16, 8, 65536, 256
        assert Hq % Hkv == 0, (Hq, Hkv)
        return {
            "x": _w((lambda *s: torch.randn(*s, dtype=torch.bfloat16) * 0.05)(B, Sq, D)),
            "k_cache": _w((lambda *s: torch.randn(*s, dtype=torch.bfloat16) * 6.4)(B, Hkv, Sk, Dh)),
            "v_cache": _w((lambda *s: torch.randn(*s, dtype=torch.bfloat16) * 0.4)(B, Hkv, Sk, Dh)),
            "wq": _w((lambda *s: torch.randn(*s, dtype=torch.bfloat16) * 6.4)(D, Hq * Dh) * (D ** -0.5)),
            "wo": _w((lambda *s: torch.randn(*s, dtype=torch.bfloat16) * 0.4)(Hq * Dh, D) * ((Hq * Dh) ** -0.5)),
        }
    _A_in = _A_setup()

    def _B_setup():
        B, S, D, F = 1, 1, 448, 1792
        return {
            "x": _w((lambda *s: torch.randn(*s, dtype=torch.bfloat16) * 0.05)(B, S, D)),
            "w1": _w((lambda *s: torch.randn(*s, dtype=torch.bfloat16) * 3.2)(D, F) * (D ** -0.5)),
            "b1": _w((lambda *s: torch.randn(*s, dtype=torch.bfloat16) * 3.2)(F) * 0.01),
            "w2": _w((lambda *s: torch.randn(*s, dtype=torch.bfloat16) * 0.2)(F, D) * (F ** -0.5)),
            "b2": _w((lambda *s: torch.randn(*s, dtype=torch.bfloat16) * 0.4)(D) * 0.01),
        }
    _B_in = _B_setup()

    return {
        "A_x": _A_in["x"],
        "A_k_cache": _A_in["k_cache"],
        "A_v_cache": _A_in["v_cache"],
        "A_wq": _A_in["wq"],
        "A_wo": _A_in["wo"],
        "B_x": _B_in["x"],
        "B_w1": _B_in["w1"],
        "B_b1": _B_in["b1"],
        "B_w2": _B_in["w2"],
        "B_b2": _B_in["b2"],
        "gate_w": _w((lambda *s: torch.randn(*s, dtype=torch.bfloat16) * 0.05)(448) * 16.0),
    }

def reference(A_x, A_k_cache, A_v_cache, A_wq, A_wo, B_x, B_w1, B_b1, B_w2, B_b2, gate_w):
    def _A_ref(x, k_cache, v_cache, wq, wo):
        B, Sq, D = x.shape
        Hq, Dh = 16, 256
        Hkv = k_cache.shape[1]
        rep = Hq // Hkv
        q = (lambda x, *d: x.permute(*d))((x @ wq).reshape(B, Sq, Hq, Dh), 0, 2, 1, 3)
        k = (lambda x, n, axis: torch.repeat_interleave(x, n, dim=axis))(k_cache, rep, axis=1)
        v = (lambda x, n, axis: torch.repeat_interleave(x, n, dim=axis))(v_cache, rep, axis=1)
        scores = torch.einsum("bhqd,bhkd->bhqk", q, k) * (Dh ** -0.5)
        p = _softmax(scores, axis=-1)
        o = torch.einsum("bhqk,bhkd->bhqd", p, v)
        return (lambda x, *d: x.permute(*d))(o, 0, 2, 1, 3).reshape(B, Sq, Hq * Dh) @ wo

    def _B_ref(x, w1, b1, w2, b2):
        h = torch.einsum("bsd,df->bsf", x, w1) + b1
        h = _gelu(h)
        return torch.einsum("bsf,fd->bsd", h, w2) + b2

    x = A_x
    g = _sigmoid((x * gate_w).sum(-1, keepdims=True))
    a = _A_ref(x, A_k_cache, A_v_cache, A_wq, A_wo)
    b = _B_ref(x, B_w1, B_b1, B_w2, B_b2)
    return g * a + (1 - g) * b
```

```asm
; @launch grid=(256,1,1) block=(1024,1,1) lds=52224
.amdgcn_target "amdgcn-amd-amdhsa--gfx950"
.text
.globl gated_mix__gqa_block_cached__dense_activation_gelu__decode_kernel
.p2align 8
.type gated_mix__gqa_block_cached__dense_activation_gelu__decode_kernel,@function
gated_mix__gqa_block_cached__dense_activation_gelu__decode_kernel:
    s_cmp_ge_u32 s2, 256
    s_cbranch_scc1 L_end
    s_load_dwordx16 s[16:31], s[0:1], 0
    s_load_dwordx8 s[32:39], s[0:1], 64
    s_load_dwordx4 s[40:43], s[0:1], 96
    v_lshrrev_b32 v1, 6, v0
    v_and_b32 v2, 63, v0
    v_readfirstlane_b32 s3, v1
    s_and_b32 s80, s2, 7
    s_lshr_b32 s81, s2, 3
    s_lshr_b32 s4, s81, 2
    s_lshl_b32 s5, s80, 2
    s_and_b32 s6, s81, 3
    s_or_b32 s5, s5, s6
    s_and_b32 s88, s3, 0
    s_mul_i32 s79, s88, 8
    s_add_u32 s79, s79, s4
    s_lshr_b32 s6, s5, 5
    s_mul_i32 s86, s6, 8
    s_add_u32 s86, s86, s4
    s_and_b32 s87, s5, 31
    s_lshl_b32 s84, s79, 12
    s_add_u32 s84, s84, 6356992
    v_and_b32 v3, 15, v2
    v_lshrrev_b32 v1, 4, v2
    v_lshlrev_b32 v59, 9, v1
    v_lshl_add_u32 v59, v3, 4, v59
    s_lshr_b32 s7, s3, 0
    s_lshr_b32 s6, s7, 2
    s_lshl_b32 s6, s6, 7
    s_and_b32 s7, s7, 3
    s_add_u32 s6, s6, s7
    s_lshl_b32 s78, s5, 2
    s_add_u32 s6, s6, s78
    s_mul_i32 s90, s79, 2048
    s_add_u32 s6, s6, s90
    s_add_u32 s7, s6, 512
    s_and_b32 s6, s6, 8191
    s_and_b32 s7, s7, 8191
    s_lshl_b32 s91, s7, 12
    s_lshl_b32 s6, s6, 12
    v_add_u32 v58, s6, v59
    s_waitcnt lgkmcnt(0)
    s_load_dword s15, s[42:43], 7936
    s_lshl_b32 s6, s79, 25
    s_add_u32 s44, s18, s6
    s_addc_u32 s45, s19, 0
    s_mov_b32 s46, 0x2000000
    s_mov_b32 s47, 0x20000
    s_add_u32 s48, s20, s6
    s_addc_u32 s49, s21, 0
    s_mov_b32 s50, 0x2000000
    s_mov_b32 s51, 0x20000
    s_mov_b32 s56, s42
    s_mov_b32 s57, s43
    s_mov_b32 s58, 0x40000000
    s_mov_b32 s59, 0x20000
    s_cmp_ge_u32 s3, 3
    s_cbranch_scc1 L_kv0
    s_setprio 3
    s_cmp_eq_u32 s3, 1
    s_cbranch_scc1 L_w1
    s_cmp_eq_u32 s3, 2
    s_cbranch_scc1 L_w2
    v_mov_b32 v62, 0
    ds_write_b32 v62, v62 offset:2060
    ds_write_b32 v62, v62 offset:2100
    s_mov_b32 s52, s22
    s_mov_b32 s53, s23
    s_mov_b32 s54, 3670016
    s_mov_b32 s55, 0x20000
    v_lshrrev_b32 v60, 1, v2
    v_lshlrev_b32 v61, 13, v60
    v_and_b32 v62, 1, v2
    v_lshl_add_u32 v61, v62, 4, v61
    s_load_dword s85, s[42:43], s84
    s_lshl_b32 s12, s86, 10
    s_lshl_b32 s13, s87, 5
    s_add_u32 s12, s12, s13
    buffer_load_dwordx4 v[64:67], v61, s[52:55], s12 offen nt
    s_add_u32 s12, s12, 262144
    buffer_load_dwordx4 v[68:71], v61, s[52:55], s12 offen nt
    s_add_u32 s12, s12, 262144
    buffer_load_dwordx4 v[72:75], v61, s[52:55], s12 offen nt
    s_add_u32 s12, s12, 262144
    buffer_load_dwordx4 v[76:79], v61, s[52:55], s12 offen nt
    s_add_u32 s12, s12, 262144
    buffer_load_dwordx4 v[80:83], v61, s[52:55], s12 offen nt
    s_add_u32 s12, s12, 262144
    buffer_load_dwordx4 v[84:87], v61, s[52:55], s12 offen nt
    s_add_u32 s12, s12, 262144
    buffer_load_dwordx4 v[88:91], v61, s[52:55], s12 offen nt
    s_add_u32 s12, s12, 262144
    buffer_load_dwordx4 v[92:95], v61, s[52:55], s12 offen nt
    s_add_u32 s12, s12, 262144
    buffer_load_dwordx4 v[96:99], v61, s[52:55], s12 offen nt
    s_add_u32 s12, s12, 262144
    buffer_load_dwordx4 v[100:103], v61, s[52:55], s12 offen nt
    s_add_u32 s12, s12, 262144
    buffer_load_dwordx4 v[104:107], v61, s[52:55], s12 offen nt
    s_add_u32 s12, s12, 262144
    buffer_load_dwordx4 v[108:111], v61, s[52:55], s12 offen nt
    s_add_u32 s12, s12, 262144
    buffer_load_dwordx4 v[112:115], v61, s[52:55], s12 offen nt
    s_add_u32 s12, s12, 262144
    buffer_load_dwordx4 v[116:119], v61, s[52:55], s12 offen nt
    v_lshlrev_b32 v60, 1, v60
    global_load_ushort v16, v60, s[16:17] offset:0
    global_load_ushort v17, v60, s[16:17] offset:64
    global_load_ushort v18, v60, s[16:17] offset:128
    global_load_ushort v19, v60, s[16:17] offset:192
    global_load_ushort v20, v60, s[16:17] offset:256
    global_load_ushort v21, v60, s[16:17] offset:320
    global_load_ushort v22, v60, s[16:17] offset:384
    global_load_ushort v23, v60, s[16:17] offset:448
    global_load_ushort v24, v60, s[16:17] offset:512
    global_load_ushort v25, v60, s[16:17] offset:576
    global_load_ushort v26, v60, s[16:17] offset:640
    global_load_ushort v27, v60, s[16:17] offset:704
    global_load_ushort v28, v60, s[16:17] offset:768
    global_load_ushort v29, v60, s[16:17] offset:832
    s_waitcnt lgkmcnt(0)
    s_barrier
    v_mov_b32 v62, 0
    s_add_u32 s13, s78, 1024
    s_lshl_b32 s13, s13, 19
    s_or_b32 s13, s13, 155648
    v_mov_b32 v60, s13
    s_add_u32 s13, s78, 5888
    s_lshl_b32 s13, s13, 19
    s_or_b32 s13, s13, 8192
    v_mov_b32 v61, s13
    ds_write_b64 v62, v[60:61] offset:2048
    s_waitcnt lgkmcnt(0)
    s_mul_i32 s10, s15, 0x9E3779B1
    s_add_u32 s10, s10, 0x7F4A7C15
    v_mov_b32 v61, s85
    ds_write_b32 v62, v61 offset:2056
    s_mov_b32 s13, 0x05040100
    s_mov_b32 s14, 0x07060302
    s_waitcnt vmcnt(0)
    v_lshl_or_b32 v16, v17, 16, v16
    v_lshl_or_b32 v18, v19, 16, v18
    v_lshl_or_b32 v20, v21, 16, v20
    v_lshl_or_b32 v22, v23, 16, v22
    v_lshl_or_b32 v24, v25, 16, v24
    v_lshl_or_b32 v26, v27, 16, v26
    v_lshl_or_b32 v28, v29, 16, v28
    v_perm_b32 v48, v68, v64, s13
    v_perm_b32 v49, v68, v64, s14
    v_perm_b32 v50, v69, v65, s13
    v_perm_b32 v51, v69, v65, s14
    v_perm_b32 v52, v70, v66, s13
    v_perm_b32 v53, v70, v66, s14
    v_perm_b32 v54, v71, v67, s13
    v_perm_b32 v55, v71, v67, s14
    v_dot2_f32_bf16 v40, v48, v16, 0
    v_dot2_f32_bf16 v41, v49, v16, 0
    v_dot2_f32_bf16 v42, v50, v16, 0
    v_dot2_f32_bf16 v43, v51, v16, 0
    v_dot2_f32_bf16 v44, v52, v16, 0
    v_dot2_f32_bf16 v45, v53, v16, 0
    v_dot2_f32_bf16 v46, v54, v16, 0
    v_dot2_f32_bf16 v47, v55, v16, 0
    v_perm_b32 v48, v76, v72, s13
    v_perm_b32 v49, v76, v72, s14
    v_perm_b32 v50, v77, v73, s13
    v_perm_b32 v51, v77, v73, s14
    v_perm_b32 v52, v78, v74, s13
    v_perm_b32 v53, v78, v74, s14
    v_perm_b32 v54, v79, v75, s13
    v_perm_b32 v55, v79, v75, s14
    v_dot2_f32_bf16 v40, v48, v18, v40
    v_dot2_f32_bf16 v41, v49, v18, v41
    v_dot2_f32_bf16 v42, v50, v18, v42
    v_dot2_f32_bf16 v43, v51, v18, v43
    v_dot2_f32_bf16 v44, v52, v18, v44
    v_dot2_f32_bf16 v45, v53, v18, v45
    v_dot2_f32_bf16 v46, v54, v18, v46
    v_dot2_f32_bf16 v47, v55, v18, v47
    v_perm_b32 v48, v84, v80, s13
    v_perm_b32 v49, v84, v80, s14
    v_perm_b32 v50, v85, v81, s13
    v_perm_b32 v51, v85, v81, s14
    v_perm_b32 v52, v86, v82, s13
    v_perm_b32 v53, v86, v82, s14
    v_perm_b32 v54, v87, v83, s13
    v_perm_b32 v55, v87, v83, s14
    v_dot2_f32_bf16 v40, v48, v20, v40
    v_dot2_f32_bf16 v41, v49, v20, v41
    v_dot2_f32_bf16 v42, v50, v20, v42
    v_dot2_f32_bf16 v43, v51, v20, v43
    v_dot2_f32_bf16 v44, v52, v20, v44
    v_dot2_f32_bf16 v45, v53, v20, v45
    v_dot2_f32_bf16 v46, v54, v20, v46
    v_dot2_f32_bf16 v47, v55, v20, v47
    v_perm_b32 v48, v92, v88, s13
    v_perm_b32 v49, v92, v88, s14
    v_perm_b32 v50, v93, v89, s13
    v_perm_b32 v51, v93, v89, s14
    v_perm_b32 v52, v94, v90, s13
    v_perm_b32 v53, v94, v90, s14
    v_perm_b32 v54, v95, v91, s13
    v_perm_b32 v55, v95, v91, s14
    v_dot2_f32_bf16 v40, v48, v22, v40
    v_dot2_f32_bf16 v41, v49, v22, v41
    v_dot2_f32_bf16 v42, v50, v22, v42
    v_dot2_f32_bf16 v43, v51, v22, v43
    v_dot2_f32_bf16 v44, v52, v22, v44
    v_dot2_f32_bf16 v45, v53, v22, v45
    v_dot2_f32_bf16 v46, v54, v22, v46
    v_dot2_f32_bf16 v47, v55, v22, v47
    v_perm_b32 v48, v100, v96, s13
    v_perm_b32 v49, v100, v96, s14
    v_perm_b32 v50, v101, v97, s13
    v_perm_b32 v51, v101, v97, s14
    v_perm_b32 v52, v102, v98, s13
    v_perm_b32 v53, v102, v98, s14
    v_perm_b32 v54, v103, v99, s13
    v_perm_b32 v55, v103, v99, s14
    v_dot2_f32_bf16 v40, v48, v24, v40
    v_dot2_f32_bf16 v41, v49, v24, v41
    v_dot2_f32_bf16 v42, v50, v24, v42
    v_dot2_f32_bf16 v43, v51, v24, v43
    v_dot2_f32_bf16 v44, v52, v24, v44
    v_dot2_f32_bf16 v45, v53, v24, v45
    v_dot2_f32_bf16 v46, v54, v24, v46
    v_dot2_f32_bf16 v47, v55, v24, v47
    v_perm_b32 v48, v108, v104, s13
    v_perm_b32 v49, v108, v104, s14
    v_perm_b32 v50, v109, v105, s13
    v_perm_b32 v51, v109, v105, s14
    v_perm_b32 v52, v110, v106, s13
    v_perm_b32 v53, v110, v106, s14
    v_perm_b32 v54, v111, v107, s13
    v_perm_b32 v55, v111, v107, s14
    v_dot2_f32_bf16 v40, v48, v26, v40
    v_dot2_f32_bf16 v41, v49, v26, v41
    v_dot2_f32_bf16 v42, v50, v26, v42
    v_dot2_f32_bf16 v43, v51, v26, v43
    v_dot2_f32_bf16 v44, v52, v26, v44
    v_dot2_f32_bf16 v45, v53, v26, v45
    v_dot2_f32_bf16 v46, v54, v26, v46
    v_dot2_f32_bf16 v47, v55, v26, v47
    v_perm_b32 v48, v116, v112, s13
    v_perm_b32 v49, v116, v112, s14
    v_perm_b32 v50, v117, v113, s13
    v_perm_b32 v51, v117, v113, s14
    v_perm_b32 v52, v118, v114, s13
    v_perm_b32 v53, v118, v114, s14
    v_perm_b32 v54, v119, v115, s13
    v_perm_b32 v55, v119, v115, s14
    v_dot2_f32_bf16 v40, v48, v28, v40
    v_dot2_f32_bf16 v41, v49, v28, v41
    v_dot2_f32_bf16 v42, v50, v28, v42
    v_dot2_f32_bf16 v43, v51, v28, v43
    v_dot2_f32_bf16 v44, v52, v28, v44
    v_dot2_f32_bf16 v45, v53, v28, v45
    v_dot2_f32_bf16 v46, v54, v28, v46
    v_dot2_f32_bf16 v47, v55, v28, v47
    s_nop 2
    v_add_f32_dpp v40, v40, v40 row_ror:8 row_mask:0xf bank_mask:0xf
    v_add_f32_dpp v41, v41, v41 row_ror:8 row_mask:0xf bank_mask:0xf
    v_add_f32_dpp v42, v42, v42 row_ror:8 row_mask:0xf bank_mask:0xf
    v_add_f32_dpp v43, v43, v43 row_ror:8 row_mask:0xf bank_mask:0xf
    v_add_f32_dpp v44, v44, v44 row_ror:8 row_mask:0xf bank_mask:0xf
    v_add_f32_dpp v45, v45, v45 row_ror:8 row_mask:0xf bank_mask:0xf
    v_add_f32_dpp v46, v46, v46 row_ror:8 row_mask:0xf bank_mask:0xf
    v_add_f32_dpp v47, v47, v47 row_ror:8 row_mask:0xf bank_mask:0xf
    v_add_f32_dpp v40, v40, v40 row_ror:4 row_mask:0xf bank_mask:0xf
    v_add_f32_dpp v41, v41, v41 row_ror:4 row_mask:0xf bank_mask:0xf
    v_add_f32_dpp v42, v42, v42 row_ror:4 row_mask:0xf bank_mask:0xf
    v_add_f32_dpp v43, v43, v43 row_ror:4 row_mask:0xf bank_mask:0xf
    v_add_f32_dpp v44, v44, v44 row_ror:4 row_mask:0xf bank_mask:0xf
    v_add_f32_dpp v45, v45, v45 row_ror:4 row_mask:0xf bank_mask:0xf
    v_add_f32_dpp v46, v46, v46 row_ror:4 row_mask:0xf bank_mask:0xf
    v_add_f32_dpp v47, v47, v47 row_ror:4 row_mask:0xf bank_mask:0xf
    v_add_f32_dpp v40, v40, v40 row_ror:2 row_mask:0xf bank_mask:0xf
    v_add_f32_dpp v41, v41, v41 row_ror:2 row_mask:0xf bank_mask:0xf
    v_add_f32_dpp v42, v42, v42 row_ror:2 row_mask:0xf bank_mask:0xf
    v_add_f32_dpp v43, v43, v43 row_ror:2 row_mask:0xf bank_mask:0xf
    v_add_f32_dpp v44, v44, v44 row_ror:2 row_mask:0xf bank_mask:0xf
    v_add_f32_dpp v45, v45, v45 row_ror:2 row_mask:0xf bank_mask:0xf
    v_add_f32_dpp v46, v46, v46 row_ror:2 row_mask:0xf bank_mask:0xf
    v_add_f32_dpp v47, v47, v47 row_ror:2 row_mask:0xf bank_mask:0xf
    v_mov_b32 v48, v40
    v_mov_b32 v49, v41
    v_mov_b32 v50, v42
    v_mov_b32 v51, v43
    v_mov_b32 v52, v44
    v_mov_b32 v53, v45
    v_mov_b32 v54, v46
    v_mov_b32 v55, v47
    s_nop 1
    v_permlane32_swap_b32 v40, v48
    v_permlane32_swap_b32 v41, v49
    v_permlane32_swap_b32 v42, v50
    v_permlane32_swap_b32 v43, v51
    v_permlane32_swap_b32 v44, v52
    v_permlane32_swap_b32 v45, v53
    v_permlane32_swap_b32 v46, v54
    v_permlane32_swap_b32 v47, v55
    v_add_f32 v40, v40, v48
    v_add_f32 v41, v41, v49
    v_add_f32 v42, v42, v50
    v_add_f32 v43, v43, v51
    v_add_f32 v44, v44, v52
    v_add_f32 v45, v45, v53
    v_add_f32 v46, v46, v54
    v_add_f32 v47, v47, v55
    v_mov_b32 v48, v40
    v_mov_b32 v49, v41
    v_mov_b32 v50, v42
    v_mov_b32 v51, v43
    v_mov_b32 v52, v44
    v_mov_b32 v53, v45
    v_mov_b32 v54, v46
    v_mov_b32 v55, v47
    s_nop 1
    v_permlane16_swap_b32 v40, v48
    v_permlane16_swap_b32 v41, v49
    v_permlane16_swap_b32 v42, v50
    v_permlane16_swap_b32 v43, v51
    v_permlane16_swap_b32 v44, v52
    v_permlane16_swap_b32 v45, v53
    v_permlane16_swap_b32 v46, v54
    v_permlane16_swap_b32 v47, v55
    v_add_f32 v40, v40, v48
    v_add_f32 v41, v41, v49
    v_add_f32 v42, v42, v50
    v_add_f32 v43, v43, v51
    v_add_f32 v44, v44, v52
    v_add_f32 v45, v45, v53
    v_add_f32 v46, v46, v54
    v_add_f32 v47, v47, v55
    v_cvt_pk_bf16_f32 v48, v40, v41
    v_mov_b32 v49, s10
    v_cvt_pk_bf16_f32 v50, v42, v43
    v_mov_b32 v51, s10
    v_cvt_pk_bf16_f32 v52, v44, v45
    v_mov_b32 v53, s10
    v_cvt_pk_bf16_f32 v54, v46, v47
    v_mov_b32 v55, s10
    v_lshlrev_b32 v60, 5, v2
    s_lshl_b32 s13, s87, 6
    s_lshl_b32 s14, s86, 11
    s_add_u32 s13, s13, s14
    s_add_u32 s13, s13, 6291456
    v_add_u32 v61, s13, v60
    s_lshl_b32 s12, s4, 11
    s_add_u32 s12, s12, 6291456
    v_add_u32 v60, s12, v60
    s_mov_b64 exec, 3
    global_store_dwordx4 v61, v[48:51], s[42:43] sc1
    global_store_dwordx4 v61, v[52:55], s[42:43] offset:16 sc1
    s_mov_b64 exec, -1
    s_mov_b32 s13, 16384
    s_mov_b32 s12, 200000
L_poll_q:
    buffer_load_dwordx4 v[16:19], v60, s[56:59], 0 offen sc1
    buffer_load_dwordx4 v[20:23], v60, s[56:59], 0 offen offset:16 sc1
    s_waitcnt vmcnt(0)
    v_xor_b32 v17, s10, v17
    v_xor_b32 v19, s10, v19
    v_xor_b32 v21, s10, v21
    v_xor_b32 v23, s10, v23
    v_or3_b32 v17, v17, v19, v21
    v_or_b32 v17, v17, v23
    v_cmp_ne_u32 vcc, 0, v17
    s_cbranch_vccz L_done_q
    s_mov_b64 exec, vcc
    s_sleep 2
    s_sub_u32 s12, s12, 1
    s_cmp_lg_u32 s12, 0
    s_cbranch_scc1 L_poll_q
L_done_q:
    s_mov_b64 exec, -1
    v_lshlrev_b32 v62, 4, v2
    v_mov_b32 v17, v18
    v_mov_b32 v18, v20
    v_mov_b32 v19, v22
    ds_write_b128 v62, v[16:19] offset:0
    v_mov_b32 v62, 0
    v_mov_b32 v61, 1
    s_waitcnt lgkmcnt(0)
    ds_write_b32 v62, v61 offset:2060
    s_branch L_kv
L_w1:
    s_cmp_ge_u32 s81, 28
    s_cbranch_scc1 L_gate
    s_mul_i32 s11, s80, 28
    s_add_u32 s11, s11, s81
    s_mov_b32 s52, s28
    s_mov_b32 s53, s29
    s_mov_b32 s54, 1605632
    s_mov_b32 s55, 0x20000
    s_lshl_b32 s13, s11, 4
    s_load_dwordx4 s[64:67], s[30:31], s13
    v_mul_u32_u24 v61, 3584, v2
    buffer_load_dwordx4 v[64:67], v61, s[52:55], s13 offen nt
    s_add_u32 s13, s13, 229376
    buffer_load_dwordx4 v[68:71], v61, s[52:55], s13 offen nt
    s_add_u32 s13, s13, 229376
    buffer_load_dwordx4 v[72:75], v61, s[52:55], s13 offen nt
    s_add_u32 s13, s13, 229376
    buffer_load_dwordx4 v[76:79], v61, s[52:55], s13 offen nt
    s_add_u32 s13, s13, 229376
    buffer_load_dwordx4 v[80:83], v61, s[52:55], s13 offen nt
    s_add_u32 s13, s13, 229376
    buffer_load_dwordx4 v[84:87], v61, s[52:55], s13 offen nt
    s_add_u32 s13, s13, 229376
    buffer_load_dwordx4 v[88:91], v61, s[52:55], s13 offen nt
    v_lshlrev_b32 v60, 1, v2
    global_load_ushort v16, v60, s[16:17] offset:0
    global_load_ushort v17, v60, s[16:17] offset:128
    global_load_ushort v18, v60, s[16:17] offset:256
    global_load_ushort v19, v60, s[16:17] offset:384
    global_load_ushort v20, v60, s[16:17] offset:512
    global_load_ushort v21, v60, s[16:17] offset:640
    global_load_ushort v22, v60, s[16:17] offset:768
    s_mul_i32 s12, s11, 7168
    s_add_u32 s12, s12, 3584
    v_lshlrev_b32 v62, 4, v2
    v_add_u32 v62, s12, v62
    s_mov_b32 exec_hi, 0x00ffffff
    global_load_dwordx4 v[92:95], v62, s[32:33] offset:-3584 nt
    global_load_dwordx4 v[96:99], v62, s[32:33] offset:-2688 nt
    global_load_dwordx4 v[100:103], v62, s[32:33] offset:-1792 nt
    global_load_dwordx4 v[104:107], v62, s[32:33] offset:-896 nt
    global_load_dwordx4 v[108:111], v62, s[32:33] offset:0 nt
    global_load_dwordx4 v[112:115], v62, s[32:33] offset:896 nt
    global_load_dwordx4 v[116:119], v62, s[32:33] offset:1792 nt
    global_load_dwordx4 v[120:123], v62, s[32:33] offset:2688 nt
    s_mov_b64 exec, -1
    s_barrier
    s_waitcnt lgkmcnt(0)
    s_mul_i32 s10, s15, 0x9E3779B1
    s_add_u32 s10, s10, 0x7F4A7C15
    s_waitcnt vmcnt(8)
    v_lshlrev_b32 v16, 16, v16
    v_lshlrev_b32 v48, 16, v64
    v_and_b32 v49, 0xffff0000, v64
    v_lshlrev_b32 v50, 16, v65
    v_and_b32 v51, 0xffff0000, v65
    v_lshlrev_b32 v52, 16, v66
    v_and_b32 v53, 0xffff0000, v66
    v_lshlrev_b32 v54, 16, v67
    v_and_b32 v55, 0xffff0000, v67
    v_mul_f32 v40, v48, v16
    v_mul_f32 v41, v49, v16
    v_mul_f32 v42, v50, v16
    v_mul_f32 v43, v51, v16
    v_mul_f32 v44, v52, v16
    v_mul_f32 v45, v53, v16
    v_mul_f32 v46, v54, v16
    v_mul_f32 v47, v55, v16
    v_lshlrev_b32 v17, 16, v17
    v_lshlrev_b32 v48, 16, v68
    v_and_b32 v49, 0xffff0000, v68
    v_lshlrev_b32 v50, 16, v69
    v_and_b32 v51, 0xffff0000, v69
    v_lshlrev_b32 v52, 16, v70
    v_and_b32 v53, 0xffff0000, v70
    v_lshlrev_b32 v54, 16, v71
    v_and_b32 v55, 0xffff0000, v71
    v_fmac_f32 v40, v48, v17
    v_fmac_f32 v41, v49, v17
    v_fmac_f32 v42, v50, v17
    v_fmac_f32 v43, v51, v17
    v_fmac_f32 v44, v52, v17
    v_fmac_f32 v45, v53, v17
    v_fmac_f32 v46, v54, v17
    v_fmac_f32 v47, v55, v17
    v_lshlrev_b32 v18, 16, v18
    v_lshlrev_b32 v48, 16, v72
    v_and_b32 v49, 0xffff0000, v72
    v_lshlrev_b32 v50, 16, v73
    v_and_b32 v51, 0xffff0000, v73
    v_lshlrev_b32 v52, 16, v74
    v_and_b32 v53, 0xffff0000, v74
    v_lshlrev_b32 v54, 16, v75
    v_and_b32 v55, 0xffff0000, v75
    v_fmac_f32 v40, v48, v18
    v_fmac_f32 v41, v49, v18
    v_fmac_f32 v42, v50, v18
    v_fmac_f32 v43, v51, v18
    v_fmac_f32 v44, v52, v18
    v_fmac_f32 v45, v53, v18
    v_fmac_f32 v46, v54, v18
    v_fmac_f32 v47, v55, v18
    v_lshlrev_b32 v19, 16, v19
    v_lshlrev_b32 v48, 16, v76
    v_and_b32 v49, 0xffff0000, v76
    v_lshlrev_b32 v50, 16, v77
    v_and_b32 v51, 0xffff0000, v77
    v_lshlrev_b32 v52, 16, v78
    v_and_b32 v53, 0xffff0000, v78
    v_lshlrev_b32 v54, 16, v79
    v_and_b32 v55, 0xffff0000, v79
    v_fmac_f32 v40, v48, v19
    v_fmac_f32 v41, v49, v19
    v_fmac_f32 v42, v50, v19
    v_fmac_f32 v43, v51, v19
    v_fmac_f32 v44, v52, v19
    v_fmac_f32 v45, v53, v19
    v_fmac_f32 v46, v54, v19
    v_fmac_f32 v47, v55, v19
    v_lshlrev_b32 v20, 16, v20
    v_lshlrev_b32 v48, 16, v80
    v_and_b32 v49, 0xffff0000, v80
    v_lshlrev_b32 v50, 16, v81
    v_and_b32 v51, 0xffff0000, v81
    v_lshlrev_b32 v52, 16, v82
    v_and_b32 v53, 0xffff0000, v82
    v_lshlrev_b32 v54, 16, v83
    v_and_b32 v55, 0xffff0000, v83
    v_fmac_f32 v40, v48, v20
    v_fmac_f32 v41, v49, v20
    v_fmac_f32 v42, v50, v20
    v_fmac_f32 v43, v51, v20
    v_fmac_f32 v44, v52, v20
    v_fmac_f32 v45, v53, v20
    v_fmac_f32 v46, v54, v20
    v_fmac_f32 v47, v55, v20
    v_lshlrev_b32 v21, 16, v21
    v_lshlrev_b32 v48, 16, v84
    v_and_b32 v49, 0xffff0000, v84
    v_lshlrev_b32 v50, 16, v85
    v_and_b32 v51, 0xffff0000, v85
    v_lshlrev_b32 v52, 16, v86
    v_and_b32 v53, 0xffff0000, v86
    v_lshlrev_b32 v54, 16, v87
    v_and_b32 v55, 0xffff0000, v87
    v_fmac_f32 v40, v48, v21
    v_fmac_f32 v41, v49, v21
    v_fmac_f32 v42, v50, v21
    v_fmac_f32 v43, v51, v21
    v_fmac_f32 v44, v52, v21
    v_fmac_f32 v45, v53, v21
    v_fmac_f32 v46, v54, v21
    v_fmac_f32 v47, v55, v21
    v_lshlrev_b32 v22, 16, v22
    v_lshlrev_b32 v48, 16, v88
    v_and_b32 v49, 0xffff0000, v88
    v_lshlrev_b32 v50, 16, v89
    v_and_b32 v51, 0xffff0000, v89
    v_lshlrev_b32 v52, 16, v90
    v_and_b32 v53, 0xffff0000, v90
    v_lshlrev_b32 v54, 16, v91
    v_and_b32 v55, 0xffff0000, v91
    v_fmac_f32 v40, v48, v22
    v_fmac_f32 v41, v49, v22
    v_fmac_f32 v42, v50, v22
    v_fmac_f32 v43, v51, v22
    v_fmac_f32 v44, v52, v22
    v_fmac_f32 v45, v53, v22
    v_fmac_f32 v46, v54, v22
    v_fmac_f32 v47, v55, v22
    v_add_f32_dpp v40, v40, v40 quad_perm:[1,0,3,2] row_mask:0xf bank_mask:0xf
    v_add_f32_dpp v41, v41, v41 quad_perm:[1,0,3,2] row_mask:0xf bank_mask:0xf
    v_add_f32_dpp v42, v42, v42 quad_perm:[1,0,3,2] row_mask:0xf bank_mask:0xf
    v_add_f32_dpp v43, v43, v43 quad_perm:[1,0,3,2] row_mask:0xf bank_mask:0xf
    v_add_f32_dpp v44, v44, v44 quad_perm:[1,0,3,2] row_mask:0xf bank_mask:0xf
    v_add_f32_dpp v45, v45, v45 quad_perm:[1,0,3,2] row_mask:0xf bank_mask:0xf
    v_add_f32_dpp v46, v46, v46 quad_perm:[1,0,3,2] row_mask:0xf bank_mask:0xf
    v_add_f32_dpp v47, v47, v47 quad_perm:[1,0,3,2] row_mask:0xf bank_mask:0xf
    v_add_f32_dpp v40, v40, v40 quad_perm:[2,3,0,1] row_mask:0xf bank_mask:0xf
    v_add_f32_dpp v41, v41, v41 quad_perm:[2,3,0,1] row_mask:0xf bank_mask:0xf
    v_add_f32_dpp v42, v42, v42 quad_perm:[2,3,0,1] row_mask:0xf bank_mask:0xf
    v_add_f32_dpp v43, v43, v43 quad_perm:[2,3,0,1] row_mask:0xf bank_mask:0xf
    v_add_f32_dpp v44, v44, v44 quad_perm:[2,3,0,1] row_mask:0xf bank_mask:0xf
    v_add_f32_dpp v45, v45, v45 quad_perm:[2,3,0,1] row_mask:0xf bank_mask:0xf
    v_add_f32_dpp v46, v46, v46 quad_perm:[2,3,0,1] row_mask:0xf bank_mask:0xf
    v_add_f32_dpp v47, v47, v47 quad_perm:[2,3,0,1] row_mask:0xf bank_mask:0xf
    v_add_f32_dpp v40, v40, v40 row_half_mirror row_mask:0xf bank_mask:0xf
    v_add_f32_dpp v41, v41, v41 row_half_mirror row_mask:0xf bank_mask:0xf
    v_add_f32_dpp v42, v42, v42 row_half_mirror row_mask:0xf bank_mask:0xf
    v_add_f32_dpp v43, v43, v43 row_half_mirror row_mask:0xf bank_mask:0xf
    v_add_f32_dpp v44, v44, v44 row_half_mirror row_mask:0xf bank_mask:0xf
    v_add_f32_dpp v45, v45, v45 row_half_mirror row_mask:0xf bank_mask:0xf
    v_add_f32_dpp v46, v46, v46 row_half_mirror row_mask:0xf bank_mask:0xf
    v_add_f32_dpp v47, v47, v47 row_half_mirror row_mask:0xf bank_mask:0xf
    v_add_f32_dpp v40, v40, v40 row_mirror row_mask:0xf bank_mask:0xf
    v_add_f32_dpp v41, v41, v41 row_mirror row_mask:0xf bank_mask:0xf
    v_add_f32_dpp v42, v42, v42 row_mirror row_mask:0xf bank_mask:0xf
    v_add_f32_dpp v43, v43, v43 row_mirror row_mask:0xf bank_mask:0xf
    v_add_f32_dpp v44, v44, v44 row_mirror row_mask:0xf bank_mask:0xf
    v_add_f32_dpp v45, v45, v45 row_mirror row_mask:0xf bank_mask:0xf
    v_add_f32_dpp v46, v46, v46 row_mirror row_mask:0xf bank_mask:0xf
    v_add_f32_dpp v47, v47, v47 row_mirror row_mask:0xf bank_mask:0xf
    v_mov_b32 v48, v40
    v_mov_b32 v49, v41
    v_mov_b32 v50, v42
    v_mov_b32 v51, v43
    v_mov_b32 v52, v44
    v_mov_b32 v53, v45
    v_mov_b32 v54, v46
    v_mov_b32 v55, v47
    s_nop 1
    v_permlane32_swap_b32 v40, v48
    v_permlane32_swap_b32 v41, v49
    v_permlane32_swap_b32 v42, v50
    v_permlane32_swap_b32 v43, v51
    v_permlane32_swap_b32 v44, v52
    v_permlane32_swap_b32 v45, v53
    v_permlane32_swap_b32 v46, v54
    v_permlane32_swap_b32 v47, v55
    v_add_f32 v40, v40, v48
    v_add_f32 v41, v41, v49
    v_add_f32 v42, v42, v50
    v_add_f32 v43, v43, v51
    v_add_f32 v44, v44, v52
    v_add_f32 v45, v45, v53
    v_add_f32 v46, v46, v54
    v_add_f32 v47, v47, v55
    v_mov_b32 v48, v40
    v_mov_b32 v49, v41
    v_mov_b32 v50, v42
    v_mov_b32 v51, v43
    v_mov_b32 v52, v44
    v_mov_b32 v53, v45
    v_mov_b32 v54, v46
    v_mov_b32 v55, v47
    s_nop 1
    v_permlane16_swap_b32 v40, v48
    v_permlane16_swap_b32 v41, v49
    v_permlane16_swap_b32 v42, v50
    v_permlane16_swap_b32 v43, v51
    v_permlane16_swap_b32 v44, v52
    v_permlane16_swap_b32 v45, v53
    v_permlane16_swap_b32 v46, v54
    v_permlane16_swap_b32 v47, v55
    v_add_f32 v40, v40, v48
    v_add_f32 v41, v41, v49
    v_add_f32 v42, v42, v50
    v_add_f32 v43, v43, v51
    v_add_f32 v44, v44, v52
    v_add_f32 v45, v45, v53
    v_add_f32 v46, v46, v54
    v_add_f32 v47, v47, v55
    v_mov_b32 v56, 0xc0135761
    s_mov_b32 s12, 0xbdd2d3e8
    s_lshl_b32 s13, s64, 16
    v_cvt_pk_bf16_f32 v40, v40, v40
    v_lshlrev_b32 v40, 16, v40
    v_add_f32 v40, s13, v40
    v_cvt_pk_bf16_f32 v40, v40, v40
    v_lshlrev_b32 v40, 16, v40
    s_and_b32 s13, s64, 0xffff0000
    v_cvt_pk_bf16_f32 v41, v41, v41
    v_lshlrev_b32 v41, 16, v41
    v_add_f32 v41, s13, v41
    v_cvt_pk_bf16_f32 v41, v41, v41
    v_lshlrev_b32 v41, 16, v41
    s_lshl_b32 s13, s65, 16
    v_cvt_pk_bf16_f32 v42, v42, v42
    v_lshlrev_b32 v42, 16, v42
    v_add_f32 v42, s13, v42
    v_cvt_pk_bf16_f32 v42, v42, v42
    v_lshlrev_b32 v42, 16, v42
    s_and_b32 s13, s65, 0xffff0000
    v_cvt_pk_bf16_f32 v43, v43, v43
    v_lshlrev_b32 v43, 16, v43
    v_add_f32 v43, s13, v43
    v_cvt_pk_bf16_f32 v43, v43, v43
    v_lshlrev_b32 v43, 16, v43
    s_lshl_b32 s13, s66, 16
    v_cvt_pk_bf16_f32 v44, v44, v44
    v_lshlrev_b32 v44, 16, v44
    v_add_f32 v44, s13, v44
    v_cvt_pk_bf16_f32 v44, v44, v44
    v_lshlrev_b32 v44, 16, v44
    s_and_b32 s13, s66, 0xffff0000
    v_cvt_pk_bf16_f32 v45, v45, v45
    v_lshlrev_b32 v45, 16, v45
    v_add_f32 v45, s13, v45
    v_cvt_pk_bf16_f32 v45, v45, v45
    v_lshlrev_b32 v45, 16, v45
    s_lshl_b32 s13, s67, 16
    v_cvt_pk_bf16_f32 v46, v46, v46
    v_lshlrev_b32 v46, 16, v46
    v_add_f32 v46, s13, v46
    v_cvt_pk_bf16_f32 v46, v46, v46
    v_lshlrev_b32 v46, 16, v46
    s_and_b32 s13, s67, 0xffff0000
    v_cvt_pk_bf16_f32 v47, v47, v47
    v_lshlrev_b32 v47, 16, v47
    v_add_f32 v47, s13, v47
    v_cvt_pk_bf16_f32 v47, v47, v47
    v_lshlrev_b32 v47, 16, v47
    v_mul_f32 v48, v40, v40
    v_mul_f32 v49, v41, v41
    v_mul_f32 v50, v42, v42
    v_mul_f32 v51, v43, v43
    v_mul_f32 v52, v44, v44
    v_mul_f32 v53, v45, v45
    v_mul_f32 v54, v46, v46
    v_mul_f32 v55, v47, v47
    v_fma_f32 v48, v48, s12, v56
    v_fma_f32 v49, v49, s12, v56
    v_fma_f32 v50, v50, s12, v56
    v_fma_f32 v51, v51, s12, v56
    v_fma_f32 v52, v52, s12, v56
    v_fma_f32 v53, v53, s12, v56
    v_fma_f32 v54, v54, s12, v56
    v_fma_f32 v55, v55, s12, v56
    v_mul_f32 v48, v48, v40
    v_mul_f32 v49, v49, v41
    v_mul_f32 v50, v50, v42
    v_mul_f32 v51, v51, v43
    v_mul_f32 v52, v52, v44
    v_mul_f32 v53, v53, v45
    v_mul_f32 v54, v54, v46
    v_mul_f32 v55, v55, v47
    v_exp_f32 v48, v48
    v_exp_f32 v49, v49
    v_exp_f32 v50, v50
    v_exp_f32 v51, v51
    v_exp_f32 v52, v52
    v_exp_f32 v53, v53
    v_exp_f32 v54, v54
    v_exp_f32 v55, v55
    v_add_f32 v48, 1.0, v48
    v_add_f32 v49, 1.0, v49
    v_add_f32 v50, 1.0, v50
    v_add_f32 v51, 1.0, v51
    v_add_f32 v52, 1.0, v52
    v_add_f32 v53, 1.0, v53
    v_add_f32 v54, 1.0, v54
    v_add_f32 v55, 1.0, v55
    v_rcp_f32 v48, v48
    v_rcp_f32 v49, v49
    v_rcp_f32 v50, v50
    v_rcp_f32 v51, v51
    v_rcp_f32 v52, v52
    v_rcp_f32 v53, v53
    v_rcp_f32 v54, v54
    v_rcp_f32 v55, v55
    v_mul_f32 v40, v40, v48
    v_mul_f32 v41, v41, v49
    v_mul_f32 v42, v42, v50
    v_mul_f32 v43, v43, v51
    v_mul_f32 v44, v44, v52
    v_mul_f32 v45, v45, v53
    v_mul_f32 v46, v46, v54
    v_mul_f32 v47, v47, v55
    v_cvt_pk_bf16_f32 v40, v40, v40
    v_lshlrev_b32 v40, 16, v40
    v_cvt_pk_bf16_f32 v41, v41, v41
    v_lshlrev_b32 v41, 16, v41
    v_cvt_pk_bf16_f32 v42, v42, v42
    v_lshlrev_b32 v42, 16, v42
    v_cvt_pk_bf16_f32 v43, v43, v43
    v_lshlrev_b32 v43, 16, v43
    v_cvt_pk_bf16_f32 v44, v44, v44
    v_lshlrev_b32 v44, 16, v44
    v_cvt_pk_bf16_f32 v45, v45, v45
    v_lshlrev_b32 v45, 16, v45
    v_cvt_pk_bf16_f32 v46, v46, v46
    v_lshlrev_b32 v46, 16, v46
    v_cvt_pk_bf16_f32 v47, v47, v47
    v_lshlrev_b32 v47, 16, v47
    s_waitcnt vmcnt(0)
    v_lshlrev_b32 v48, 16, v92
    v_and_b32 v49, 0xffff0000, v92
    v_lshlrev_b32 v50, 16, v93
    v_and_b32 v51, 0xffff0000, v93
    v_lshlrev_b32 v52, 16, v94
    v_and_b32 v53, 0xffff0000, v94
    v_lshlrev_b32 v54, 16, v95
    v_and_b32 v55, 0xffff0000, v95
    v_mul_f32 v64, v48, v40
    v_mul_f32 v66, v49, v40
    v_mul_f32 v68, v50, v40
    v_mul_f32 v70, v51, v40
    v_mul_f32 v72, v52, v40
    v_mul_f32 v74, v53, v40
    v_mul_f32 v76, v54, v40
    v_mul_f32 v78, v55, v40
    v_lshlrev_b32 v48, 16, v96
    v_and_b32 v49, 0xffff0000, v96
    v_lshlrev_b32 v50, 16, v97
    v_and_b32 v51, 0xffff0000, v97
    v_lshlrev_b32 v52, 16, v98
    v_and_b32 v53, 0xffff0000, v98
    v_lshlrev_b32 v54, 16, v99
    v_and_b32 v55, 0xffff0000, v99
    v_fmac_f32 v64, v48, v41
    v_fmac_f32 v66, v49, v41
    v_fmac_f32 v68, v50, v41
    v_fmac_f32 v70, v51, v41
    v_fmac_f32 v72, v52, v41
    v_fmac_f32 v74, v53, v41
    v_fmac_f32 v76, v54, v41
    v_fmac_f32 v78, v55, v41
    v_lshlrev_b32 v48, 16, v100
    v_and_b32 v49, 0xffff0000, v100
    v_lshlrev_b32 v50, 16, v101
    v_and_b32 v51, 0xffff0000, v101
    v_lshlrev_b32 v52, 16, v102
    v_and_b32 v53, 0xffff0000, v102
    v_lshlrev_b32 v54, 16, v103
    v_and_b32 v55, 0xffff0000, v103
    v_fmac_f32 v64, v48, v42
    v_fmac_f32 v66, v49, v42
    v_fmac_f32 v68, v50, v42
    v_fmac_f32 v70, v51, v42
    v_fmac_f32 v72, v52, v42
    v_fmac_f32 v74, v53, v42
    v_fmac_f32 v76, v54, v42
    v_fmac_f32 v78, v55, v42
    v_lshlrev_b32 v48, 16, v104
    v_and_b32 v49, 0xffff0000, v104
    v_lshlrev_b32 v50, 16, v105
    v_and_b32 v51, 0xffff0000, v105
    v_lshlrev_b32 v52, 16, v106
    v_and_b32 v53, 0xffff0000, v106
    v_lshlrev_b32 v54, 16, v107
    v_and_b32 v55, 0xffff0000, v107
    v_fmac_f32 v64, v48, v43
    v_fmac_f32 v66, v49, v43
    v_fmac_f32 v68, v50, v43
    v_fmac_f32 v70, v51, v43
    v_fmac_f32 v72, v52, v43
    v_fmac_f32 v74, v53, v43
    v_fmac_f32 v76, v54, v43
    v_fmac_f32 v78, v55, v43
    v_lshlrev_b32 v48, 16, v108
    v_and_b32 v49, 0xffff0000, v108
    v_lshlrev_b32 v50, 16, v109
    v_and_b32 v51, 0xffff0000, v109
    v_lshlrev_b32 v52, 16, v110
    v_and_b32 v53, 0xffff0000, v110
    v_lshlrev_b32 v54, 16, v111
    v_and_b32 v55, 0xffff0000, v111
    v_fmac_f32 v64, v48, v44
    v_fmac_f32 v66, v49, v44
    v_fmac_f32 v68, v50, v44
    v_fmac_f32 v70, v51, v44
    v_fmac_f32 v72, v52, v44
    v_fmac_f32 v74, v53, v44
    v_fmac_f32 v76, v54, v44
    v_fmac_f32 v78, v55, v44
    v_lshlrev_b32 v48, 16, v112
    v_and_b32 v49, 0xffff0000, v112
    v_lshlrev_b32 v50, 16, v113
    v_and_b32 v51, 0xffff0000, v113
    v_lshlrev_b32 v52, 16, v114
    v_and_b32 v53, 0xffff0000, v114
    v_lshlrev_b32 v54, 16, v115
    v_and_b32 v55, 0xffff0000, v115
    v_fmac_f32 v64, v48, v45
    v_fmac_f32 v66, v49, v45
    v_fmac_f32 v68, v50, v45
    v_fmac_f32 v70, v51, v45
    v_fmac_f32 v72, v52, v45
    v_fmac_f32 v74, v53, v45
    v_fmac_f32 v76, v54, v45
    v_fmac_f32 v78, v55, v45
    v_lshlrev_b32 v48, 16, v116
    v_and_b32 v49, 0xffff0000, v116
    v_lshlrev_b32 v50, 16, v117
    v_and_b32 v51, 0xffff0000, v117
    v_lshlrev_b32 v52, 16, v118
    v_and_b32 v53, 0xffff0000, v118
    v_lshlrev_b32 v54, 16, v119
    v_and_b32 v55, 0xffff0000, v119
    v_fmac_f32 v64, v48, v46
    v_fmac_f32 v66, v49, v46
    v_fmac_f32 v68, v50, v46
    v_fmac_f32 v70, v51, v46
    v_fmac_f32 v72, v52, v46
    v_fmac_f32 v74, v53, v46
    v_fmac_f32 v76, v54, v46
    v_fmac_f32 v78, v55, v46
    v_lshlrev_b32 v48, 16, v120
    v_and_b32 v49, 0xffff0000, v120
    v_lshlrev_b32 v50, 16, v121
    v_and_b32 v51, 0xffff0000, v121
    v_lshlrev_b32 v52, 16, v122
    v_and_b32 v53, 0xffff0000, v122
    v_lshlrev_b32 v54, 16, v123
    v_and_b32 v55, 0xffff0000, v123
    v_fmac_f32 v64, v48, v47
    v_fmac_f32 v66, v49, v47
    v_fmac_f32 v68, v50, v47
    v_fmac_f32 v70, v51, v47
    v_fmac_f32 v72, v52, v47
    v_fmac_f32 v74, v53, v47
    v_fmac_f32 v76, v54, v47
    v_fmac_f32 v78, v55, v47
    v_mov_b32 v65, s10
    v_mov_b32 v67, s10
    v_mov_b32 v69, s10
    v_mov_b32 v71, s10
    v_mov_b32 v73, s10
    v_mov_b32 v75, s10
    v_mov_b32 v77, s10
    v_mov_b32 v79, s10
    s_lshl_b32 s12, s11, 12
    s_add_u32 s12, s12, 5242880
    v_lshlrev_b32 v62, 6, v2
    v_add_u32 v62, s12, v62
    s_mov_b32 exec_hi, 0x00ffffff
    global_store_dwordx4 v62, v[64:67], s[42:43] offset:0 sc1
    global_store_dwordx4 v62, v[68:71], s[42:43] offset:16 sc1
    global_store_dwordx4 v62, v[72:75], s[42:43] offset:32 sc1
    global_store_dwordx4 v62, v[76:79], s[42:43] offset:48 sc1
    s_mov_b64 exec, -1
    s_waitcnt vmcnt(0)
    s_branch L_kv
L_gate:
    v_mov_b32 v16, 0
    v_mov_b32 v17, 0
    v_mov_b32 v18, 0
    v_mov_b32 v19, 0
    v_mov_b32 v20, 0
    v_mov_b32 v21, 0
    v_mov_b32 v22, 0
    v_mov_b32 v23, 0
    v_lshlrev_b32 v62, 4, v2
    s_mov_b32 exec_hi, 0x00ffffff
    global_load_dwordx4 v[16:19], v62, s[16:17]
    global_load_dwordx4 v[20:23], v62, s[36:37]
    s_mov_b64 exec, -1
    s_barrier
    s_waitcnt vmcnt(0)
    v_lshlrev_b32 v40, 16, v16
    v_and_b32 v41, 0xffff0000, v16
    v_lshlrev_b32 v42, 16, v20
    v_and_b32 v43, 0xffff0000, v20
    v_mul_f32 v40, v40, v42
    v_mul_f32 v41, v41, v43
    v_cvt_pk_bf16_f32 v40, v40, v41
    v_lshlrev_b32 v42, 16, v40
    v_and_b32 v43, 0xffff0000, v40
    v_add_f32 v44, v42, v43
    v_lshlrev_b32 v40, 16, v17
    v_and_b32 v41, 0xffff0000, v17
    v_lshlrev_b32 v42, 16, v21
    v_and_b32 v43, 0xffff0000, v21
    v_mul_f32 v40, v40, v42
    v_mul_f32 v41, v41, v43
    v_cvt_pk_bf16_f32 v40, v40, v41
    v_lshlrev_b32 v42, 16, v40
    v_and_b32 v43, 0xffff0000, v40
    v_add_f32 v44, v44, v42
    v_add_f32 v44, v44, v43
    v_lshlrev_b32 v40, 16, v18
    v_and_b32 v41, 0xffff0000, v18
    v_lshlrev_b32 v42, 16, v22
    v_and_b32 v43, 0xffff0000, v22
    v_mul_f32 v40, v40, v42
    v_mul_f32 v41, v41, v43
    v_cvt_pk_bf16_f32 v40, v40, v41
    v_lshlrev_b32 v42, 16, v40
    v_and_b32 v43, 0xffff0000, v40
    v_add_f32 v44, v44, v42
    v_add_f32 v44, v44, v43
    v_lshlrev_b32 v40, 16, v19
    v_and_b32 v41, 0xffff0000, v19
    v_lshlrev_b32 v42, 16, v23
    v_and_b32 v43, 0xffff0000, v23
    v_mul_f32 v40, v40, v42
    v_mul_f32 v41, v41, v43
    v_cvt_pk_bf16_f32 v40, v40, v41
    v_lshlrev_b32 v42, 16, v40
    v_and_b32 v43, 0xffff0000, v40
    v_add_f32 v44, v44, v42
    v_add_f32 v44, v44, v43
    s_nop 1
    v_add_f32_dpp v44, v44, v44 quad_perm:[1,0,3,2] row_mask:0xf bank_mask:0xf
    s_nop 1
    v_add_f32_dpp v44, v44, v44 quad_perm:[2,3,0,1] row_mask:0xf bank_mask:0xf
    s_nop 1
    v_add_f32_dpp v44, v44, v44 row_half_mirror row_mask:0xf bank_mask:0xf
    s_nop 1
    v_add_f32_dpp v44, v44, v44 row_mirror row_mask:0xf bank_mask:0xf
    v_mov_b32 v45, v44
    s_nop 1
    v_permlane32_swap_b32 v44, v45
    v_add_f32 v44, v44, v45
    v_mov_b32 v45, v44
    s_nop 1
    v_permlane16_swap_b32 v44, v45
    v_add_f32 v44, v44, v45
    v_cvt_pk_bf16_f32 v44, v44, v44
    v_lshlrev_b32 v44, 16, v44
    v_mul_f32 v44, 0xbfb8aa3b, v44
    v_exp_f32 v44, v44
    s_nop 0
    v_add_f32 v44, 1.0, v44
    v_rcp_f32 v44, v44
    s_nop 0
    v_cvt_pk_bf16_f32 v44, v44, v44
    v_lshlrev_b32 v44, 16, v44
    v_mov_b32 v62, 0
    s_mov_b64 exec, 1
    ds_write_b32 v62, v44 offset:2096
    s_mov_b64 exec, -1
    s_branch L_kv
L_w2:
    s_mov_b32 s52, s24
    s_mov_b32 s53, s25
    s_mov_b32 s54, 3670016
    s_mov_b32 s55, 0x20000
    s_lshl_b32 s12, s86, 5
    s_add_u32 s12, s12, s87
    s_mul_i32 s12, s12, 14336
    v_lshlrev_b32 v62, 4, v2
    s_mov_b32 m0, 4736
    s_nop 0
    buffer_load_dwordx4 v62, s[52:55], s12 offen offset:0 nt lds
    buffer_load_dwordx4 v62, s[52:55], s12 offen offset:1024 nt lds
    buffer_load_dwordx4 v62, s[52:55], s12 offen offset:2048 nt lds
    buffer_load_dwordx4 v62, s[52:55], s12 offen offset:3072 nt lds
    s_mov_b32 m0, 8832
    s_add_u32 s12, s12, 4096
    buffer_load_dwordx4 v62, s[52:55], s12 offen offset:0 nt lds
    buffer_load_dwordx4 v62, s[52:55], s12 offen offset:1024 nt lds
    buffer_load_dwordx4 v62, s[52:55], s12 offen offset:2048 nt lds
    buffer_load_dwordx4 v62, s[52:55], s12 offen offset:3072 nt lds
    s_mov_b32 m0, 12928
    s_add_u32 s12, s12, 4096
    buffer_load_dwordx4 v62, s[52:55], s12 offen offset:0 nt lds
    buffer_load_dwordx4 v62, s[52:55], s12 offen offset:1024 nt lds
    buffer_load_dwordx4 v62, s[52:55], s12 offen offset:2048 nt lds
    buffer_load_dwordx4 v62, s[52:55], s12 offen offset:3072 nt lds
    s_mov_b32 m0, 17024
    s_add_u32 s12, s12, 4096
    buffer_load_dwordx4 v62, s[52:55], s12 offen offset:0 nt lds
    buffer_load_dwordx4 v62, s[52:55], s12 offen offset:1024 nt lds
L_kv0:
    s_barrier
L_kv:
    s_setprio 2
    buffer_load_dwordx4 v[64:67], v58, s[44:47], 0 offen offset:0 nt
    buffer_load_dwordx4 v[68:71], v58, s[44:47], 0 offen offset:256 nt
    buffer_load_dwordx4 v[72:75], v58, s[44:47], 0 offen offset:2048 nt
    buffer_load_dwordx4 v[76:79], v58, s[44:47], 0 offen offset:2304 nt
    buffer_load_dwordx4 v[80:83], v58, s[48:51], 0 offen offset:0 nt
    buffer_load_dwordx4 v[84:87], v58, s[48:51], 0 offen offset:256 nt
    buffer_load_dwordx4 v[88:91], v58, s[48:51], 0 offen offset:2048 nt
    buffer_load_dwordx4 v[92:95], v58, s[48:51], 0 offen offset:2304 nt
    v_add_u32 v58, s91, v59
    buffer_load_dwordx4 v[96:99], v58, s[44:47], 0 offen offset:0 nt
    buffer_load_dwordx4 v[100:103], v58, s[44:47], 0 offen offset:256 nt
    buffer_load_dwordx4 v[104:107], v58, s[44:47], 0 offen offset:2048 nt
    buffer_load_dwordx4 v[108:111], v58, s[44:47], 0 offen offset:2304 nt
    buffer_load_dwordx4 v[112:115], v58, s[48:51], 0 offen offset:0 nt
    buffer_load_dwordx4 v[116:119], v58, s[48:51], 0 offen offset:256 nt
    buffer_load_dwordx4 v[120:123], v58, s[48:51], 0 offen offset:2048 nt
    buffer_load_dwordx4 v[124:127], v58, s[48:51], 0 offen offset:2304 nt
    s_setprio 0
    v_and_b32 v56, 1, v2
    v_lshlrev_b32 v56, 4, v56
    v_mov_b32 v57, 0xffff
    v_lshlrev_b32 v57, v56, v57
    v_bfe_u32 v56, v2, 1, 2
    v_cmp_eq_u32 vcc, 0, v56
    s_nop 1
    v_cndmask_b32 v4, 0, v57, vcc
    v_cmp_eq_u32 vcc, 1, v56
    s_nop 1
    v_cndmask_b32 v5, 0, v57, vcc
    v_cmp_eq_u32 vcc, 2, v56
    s_nop 1
    v_cndmask_b32 v6, 0, v57, vcc
    v_cmp_eq_u32 vcc, 3, v56
    s_nop 1
    v_cndmask_b32 v7, 0, v57, vcc
    s_mov_b32 s9, 0x3db8aa3b
    v_mov_b32 v8, 0
    v_mov_b32 v9, 0
    v_mov_b32 v10, 0
    v_mov_b32 v11, 0
    v_mov_b32 v12, 0
    v_mov_b32 v13, 0
    v_mov_b32 v14, 0
    v_mov_b32 v15, 0
    v_mov_b32 v33, 0xff800000
    v_mov_b32 v34, 0xff800000
    v_mov_b32 v35, 0
    s_lshl_b32 s12, s88, 4
    v_mov_b32 v62, s12
    v_mov_b32 v61, 1
    s_mov_b32 s82, 0
    s_waitcnt lgkmcnt(0)
    s_mul_i32 s10, s15, 0x9E3779B1
    s_add_u32 s10, s10, 0x7F4A7C15
    s_mov_b32 s12, 4000000
L_qwait:
    ds_read_b32 v56, v62 offset:2060
    s_waitcnt lgkmcnt(0)
    v_readfirstlane_b32 s13, v56
    s_cmp_eq_u32 s13, 1
    s_cbranch_scc1 L_qready
    s_sleep 1
    s_sub_u32 s12, s12, 1
    s_cmp_lg_u32 s12, 0
    s_cbranch_scc1 L_qwait
L_qready:
    ds_read_b32 v56, v62 offset:2056
    v_lshlrev_b32 v57, 4, v3
    v_lshl_add_u32 v57, v62, 6, v57
    ds_read_b128 v[16:19], v57 offset:0
    ds_read_b128 v[20:23], v57 offset:256
    ds_read_b128 v[24:27], v57 offset:512
    ds_read_b128 v[28:31], v57 offset:768
    s_waitcnt lgkmcnt(0)
    v_readfirstlane_b32 s85, v56
L_loop:
    s_cmp_ge_u32 s3, 2
    s_cbranch_scc1 L_drain0
    s_mov_b64 exec, 1
    ds_add_rtn_u32 v60, v62, v61 offset:2048
    s_mov_b64 exec, -1
L_chk0:
    s_waitcnt lgkmcnt(0)
    v_readfirstlane_b32 s14, v60
    s_and_b32 s13, s14, 0xfff
    s_bfe_u32 s6, s14, 0x7000c
    s_lshr_b32 s12, s14, 19
    s_lshl_b32 s6, s6, 2
    s_cmp_ge_u32 s13, s6
    s_cbranch_scc1 L_slow0
L_ok0:
    s_lshr_b32 s6, s13, 2
    s_lshl_b32 s6, s6, 7
    s_and_b32 s13, s13, 3
    s_add_u32 s12, s12, s13
    s_add_u32 s12, s12, s6
    s_add_u32 s12, s12, s90
    s_and_b32 s12, s12, 8191
    s_lshl_b32 s12, s12, 12
    v_add_u32 v58, s12, v59
    s_waitcnt vmcnt(12)
    v_dot2_f32_bf16 v36, v64, v16, 0
    v_dot2_f32_bf16 v37, v64, v24, 0
    v_dot2_f32_bf16 v38, v72, v16, 0
    v_dot2_f32_bf16 v39, v72, v24, 0
    v_dot2_f32_bf16 v36, v65, v17, v36
    v_dot2_f32_bf16 v37, v65, v25, v37
    v_dot2_f32_bf16 v38, v73, v17, v38
    v_dot2_f32_bf16 v39, v73, v25, v39
    v_dot2_f32_bf16 v36, v66, v18, v36
    v_dot2_f32_bf16 v37, v66, v26, v37
    v_dot2_f32_bf16 v38, v74, v18, v38
    v_dot2_f32_bf16 v39, v74, v26, v39
    v_dot2_f32_bf16 v36, v67, v19, v36
    v_dot2_f32_bf16 v37, v67, v27, v37
    v_dot2_f32_bf16 v38, v75, v19, v38
    v_dot2_f32_bf16 v39, v75, v27, v39
    v_dot2_f32_bf16 v36, v68, v20, v36
    v_dot2_f32_bf16 v37, v68, v28, v37
    v_dot2_f32_bf16 v38, v76, v20, v38
    v_dot2_f32_bf16 v39, v76, v28, v39
    v_dot2_f32_bf16 v36, v69, v21, v36
    v_dot2_f32_bf16 v37, v69, v29, v37
    v_dot2_f32_bf16 v38, v77, v21, v38
    v_dot2_f32_bf16 v39, v77, v29, v39
    v_dot2_f32_bf16 v36, v70, v22, v36
    v_dot2_f32_bf16 v37, v70, v30, v37
    v_dot2_f32_bf16 v38, v78, v22, v38
    v_dot2_f32_bf16 v39, v78, v30, v39
    v_dot2_f32_bf16 v36, v71, v23, v36
    v_dot2_f32_bf16 v37, v71, v31, v37
    v_dot2_f32_bf16 v38, v79, v23, v38
    v_dot2_f32_bf16 v39, v79, v31, v39
    buffer_load_dwordx4 v[64:67], v58, s[44:47], 0 offen offset:0 nt
    buffer_load_dwordx4 v[68:71], v58, s[44:47], 0 offen offset:256 nt
    buffer_load_dwordx4 v[72:75], v58, s[44:47], 0 offen offset:2048 nt
    buffer_load_dwordx4 v[76:79], v58, s[44:47], 0 offen offset:2304 nt
    v_add_f32_dpp v40, v36, v36 row_ror:8 row_mask:0xf bank_mask:0x3
    v_add_f32_dpp v41, v38, v38 row_ror:8 row_mask:0xf bank_mask:0x3
    v_add_f32_dpp v40, v37, v37 row_ror:8 row_mask:0xf bank_mask:0xc
    v_add_f32_dpp v41, v39, v39 row_ror:8 row_mask:0xf bank_mask:0xc
    s_nop 0
    v_add_f32_dpp v40, v40, v40 row_half_mirror row_mask:0xf bank_mask:0xf
    v_add_f32_dpp v41, v41, v41 row_half_mirror row_mask:0xf bank_mask:0xf
    s_nop 0
    v_add_f32_dpp v40, v40, v40 quad_perm:[1,0,3,2] row_mask:0xf bank_mask:0xf
    v_add_f32_dpp v41, v41, v41 quad_perm:[1,0,3,2] row_mask:0xf bank_mask:0xf
    s_nop 0
    v_add_f32_dpp v40, v40, v40 quad_perm:[2,3,0,1] row_mask:0xf bank_mask:0xf
    v_add_f32_dpp v41, v41, v41 quad_perm:[2,3,0,1] row_mask:0xf bank_mask:0xf
    v_cvt_pk_bf16_f32 v42, v40, v41
    v_lshlrev_b32 v43, 16, v42
    v_and_b32 v44, 0xffff0000, v42
    v_max_f32 v45, v43, v44
    v_cmp_gt_f32 vcc, v45, v33
    s_cbranch_vccz L_nomax0
    v_max_f32 v45, v45, v33
    v_mov_b32 v56, v45
    s_nop 1
    v_permlane32_swap_b32 v45, v56
    v_max_f32 v45, v45, v56
    v_mov_b32 v56, v45
    s_nop 1
    v_permlane16_swap_b32 v45, v56
    v_max_f32 v45, v45, v56
    v_sub_f32 v57, v33, v45
    v_mul_f32 v57, s9, v57
    v_exp_f32 v57, v57
    v_mov_b32 v33, v45
    v_mul_f32 v34, s9, v45
    v_mul_f32 v35, v35, v57
    v_mov_b32 v32, v57
    s_nop 1
    v_mov_b32_dpp v32, v57 row_ror:8 row_mask:0x3 bank_mask:0xc
    v_mov_b32_dpp v32, v57 row_ror:8 row_mask:0xc bank_mask:0x3
    v_mul_f32 v8, v8, v32
    v_mul_f32 v9, v9, v32
    v_mul_f32 v10, v10, v32
    v_mul_f32 v11, v11, v32
    v_mul_f32 v12, v12, v32
    v_mul_f32 v13, v13, v32
    v_mul_f32 v14, v14, v32
    v_mul_f32 v15, v15, v32
L_nomax0:
    v_fma_f32 v46, v43, s9, -v34
    v_fma_f32 v47, v44, s9, -v34
    v_exp_f32 v46, v46
    v_exp_f32 v47, v47
    s_nop 0
    v_cvt_pk_bf16_f32 v56, v46, v46
    v_cvt_pk_bf16_f32 v57, v47, v47
    v_and_b32 v48, v56, v4
    v_and_b32 v49, v56, v5
    v_and_b32 v50, v56, v6
    v_and_b32 v51, v56, v7
    v_and_b32 v52, v57, v4
    v_and_b32 v53, v57, v5
    v_and_b32 v54, v57, v6
    v_and_b32 v55, v57, v7
    v_add_f32 v35, v35, v46
    v_add_f32 v35, v35, v47
    s_waitcnt vmcnt(12)
    v_mfma_f32_16x16x32_bf16 v[8:11], v[48:51], v[80:83], v[8:11]
    v_mfma_f32_16x16x32_bf16 v[12:15], v[48:51], v[84:87], v[12:15]
    v_mfma_f32_16x16x32_bf16 v[8:11], v[52:55], v[88:91], v[8:11]
    v_mfma_f32_16x16x32_bf16 v[12:15], v[52:55], v[92:95], v[12:15]
    buffer_load_dwordx4 v[80:83], v58, s[48:51], 0 offen offset:0 nt
    buffer_load_dwordx4 v[84:87], v58, s[48:51], 0 offen offset:256 nt
    buffer_load_dwordx4 v[88:91], v58, s[48:51], 0 offen offset:2048 nt
    buffer_load_dwordx4 v[92:95], v58, s[48:51], 0 offen offset:2304 nt
    s_cmp_eq_u32 s82, 0
    s_cbranch_scc1 L_nopend0
    s_waitcnt lgkmcnt(0)
    s_sub_u32 s83, s83, s85
    s_min_u32 s83, s83, 0x4000
    s_lshr_b32 s12, s83, 5
    s_mul_i32 s12, s12, 128
    s_and_b32 s13, s83, 31
    s_lshl_b32 s13, s13, 2
    s_add_u32 s12, s12, s13
    s_add_u32 s12, s12, 6144
    s_lshl_b32 s13, s12, 19
    s_or_b32 s13, s13, 4096
    s_cmp_ge_u32 s12, 8192
    s_cselect_b32 s83, 0xfff80001, s13
    v_mov_b32 v56, s83
    ds_write_b32 v62, v56 offset:2052
    s_mov_b32 s82, 0
L_nopend0:
    s_cmp_ge_u32 s3, 2
    s_cbranch_scc1 L_drain1
    s_mov_b64 exec, 1
    ds_add_rtn_u32 v60, v62, v61 offset:2048
    s_mov_b64 exec, -1
L_chk1:
    s_waitcnt lgkmcnt(0)
    v_readfirstlane_b32 s14, v60
    s_and_b32 s13, s14, 0xfff
    s_bfe_u32 s6, s14, 0x7000c
    s_lshr_b32 s12, s14, 19
    s_lshl_b32 s6, s6, 2
    s_cmp_ge_u32 s13, s6
    s_cbranch_scc1 L_slow1
L_ok1:
    s_lshr_b32 s6, s13, 2
    s_lshl_b32 s6, s6, 7
    s_and_b32 s13, s13, 3
    s_add_u32 s12, s12, s13
    s_add_u32 s12, s12, s6
    s_add_u32 s12, s12, s90
    s_and_b32 s12, s12, 8191
    s_lshl_b32 s12, s12, 12
    v_add_u32 v58, s12, v59
    s_waitcnt vmcnt(12)
    v_dot2_f32_bf16 v36, v96, v16, 0
    v_dot2_f32_bf16 v37, v96, v24, 0
    v_dot2_f32_bf16 v38, v104, v16, 0
    v_dot2_f32_bf16 v39, v104, v24, 0
    v_dot2_f32_bf16 v36, v97, v17, v36
    v_dot2_f32_bf16 v37, v97, v25, v37
    v_dot2_f32_bf16 v38, v105, v17, v38
    v_dot2_f32_bf16 v39, v105, v25, v39
    v_dot2_f32_bf16 v36, v98, v18, v36
    v_dot2_f32_bf16 v37, v98, v26, v37
    v_dot2_f32_bf16 v38, v106, v18, v38
    v_dot2_f32_bf16 v39, v106, v26, v39
    v_dot2_f32_bf16 v36, v99, v19, v36
    v_dot2_f32_bf16 v37, v99, v27, v37
    v_dot2_f32_bf16 v38, v107, v19, v38
    v_dot2_f32_bf16 v39, v107, v27, v39
    v_dot2_f32_bf16 v36, v100, v20, v36
    v_dot2_f32_bf16 v37, v100, v28, v37
    v_dot2_f32_bf16 v38, v108, v20, v38
    v_dot2_f32_bf16 v39, v108, v28, v39
    v_dot2_f32_bf16 v36, v101, v21, v36
    v_dot2_f32_bf16 v37, v101, v29, v37
    v_dot2_f32_bf16 v38, v109, v21, v38
    v_dot2_f32_bf16 v39, v109, v29, v39
    v_dot2_f32_bf16 v36, v102, v22, v36
    v_dot2_f32_bf16 v37, v102, v30, v37
    v_dot2_f32_bf16 v38, v110, v22, v38
    v_dot2_f32_bf16 v39, v110, v30, v39
    v_dot2_f32_bf16 v36, v103, v23, v36
    v_dot2_f32_bf16 v37, v103, v31, v37
    v_dot2_f32_bf16 v38, v111, v23, v38
    v_dot2_f32_bf16 v39, v111, v31, v39
    buffer_load_dwordx4 v[96:99], v58, s[44:47], 0 offen offset:0 nt
    buffer_load_dwordx4 v[100:103], v58, s[44:47], 0 offen offset:256 nt
    buffer_load_dwordx4 v[104:107], v58, s[44:47], 0 offen offset:2048 nt
    buffer_load_dwordx4 v[108:111], v58, s[44:47], 0 offen offset:2304 nt
    v_add_f32_dpp v40, v36, v36 row_ror:8 row_mask:0xf bank_mask:0x3
    v_add_f32_dpp v41, v38, v38 row_ror:8 row_mask:0xf bank_mask:0x3
    v_add_f32_dpp v40, v37, v37 row_ror:8 row_mask:0xf bank_mask:0xc
    v_add_f32_dpp v41, v39, v39 row_ror:8 row_mask:0xf bank_mask:0xc
    s_nop 0
    v_add_f32_dpp v40, v40, v40 row_half_mirror row_mask:0xf bank_mask:0xf
    v_add_f32_dpp v41, v41, v41 row_half_mirror row_mask:0xf bank_mask:0xf
    s_nop 0
    v_add_f32_dpp v40, v40, v40 quad_perm:[1,0,3,2] row_mask:0xf bank_mask:0xf
    v_add_f32_dpp v41, v41, v41 quad_perm:[1,0,3,2] row_mask:0xf bank_mask:0xf
    s_nop 0
    v_add_f32_dpp v40, v40, v40 quad_perm:[2,3,0,1] row_mask:0xf bank_mask:0xf
    v_add_f32_dpp v41, v41, v41 quad_perm:[2,3,0,1] row_mask:0xf bank_mask:0xf
    v_cvt_pk_bf16_f32 v42, v40, v41
    v_lshlrev_b32 v43, 16, v42
    v_and_b32 v44, 0xffff0000, v42
    v_max_f32 v45, v43, v44
    v_cmp_gt_f32 vcc, v45, v33
    s_cbranch_vccz L_nomax1
    v_max_f32 v45, v45, v33
    v_mov_b32 v56, v45
    s_nop 1
    v_permlane32_swap_b32 v45, v56
    v_max_f32 v45, v45, v56
    v_mov_b32 v56, v45
    s_nop 1
    v_permlane16_swap_b32 v45, v56
    v_max_f32 v45, v45, v56
    v_sub_f32 v57, v33, v45
    v_mul_f32 v57, s9, v57
    v_exp_f32 v57, v57
    v_mov_b32 v33, v45
    v_mul_f32 v34, s9, v45
    v_mul_f32 v35, v35, v57
    v_mov_b32 v32, v57
    s_nop 1
    v_mov_b32_dpp v32, v57 row_ror:8 row_mask:0x3 bank_mask:0xc
    v_mov_b32_dpp v32, v57 row_ror:8 row_mask:0xc bank_mask:0x3
    v_mul_f32 v8, v8, v32
    v_mul_f32 v9, v9, v32
    v_mul_f32 v10, v10, v32
    v_mul_f32 v11, v11, v32
    v_mul_f32 v12, v12, v32
    v_mul_f32 v13, v13, v32
    v_mul_f32 v14, v14, v32
    v_mul_f32 v15, v15, v32
L_nomax1:
    v_fma_f32 v46, v43, s9, -v34
    v_fma_f32 v47, v44, s9, -v34
    v_exp_f32 v46, v46
    v_exp_f32 v47, v47
    s_nop 0
    v_cvt_pk_bf16_f32 v56, v46, v46
    v_cvt_pk_bf16_f32 v57, v47, v47
    v_and_b32 v48, v56, v4
    v_and_b32 v49, v56, v5
    v_and_b32 v50, v56, v6
    v_and_b32 v51, v56, v7
    v_and_b32 v52, v57, v4
    v_and_b32 v53, v57, v5
    v_and_b32 v54, v57, v6
    v_and_b32 v55, v57, v7
    v_add_f32 v35, v35, v46
    v_add_f32 v35, v35, v47
    s_waitcnt vmcnt(12)
    v_mfma_f32_16x16x32_bf16 v[8:11], v[48:51], v[112:115], v[8:11]
    v_mfma_f32_16x16x32_bf16 v[12:15], v[48:51], v[116:119], v[12:15]
    v_mfma_f32_16x16x32_bf16 v[8:11], v[52:55], v[120:123], v[8:11]
    v_mfma_f32_16x16x32_bf16 v[12:15], v[52:55], v[124:127], v[12:15]
    buffer_load_dwordx4 v[112:115], v58, s[48:51], 0 offen offset:0 nt
    buffer_load_dwordx4 v[116:119], v58, s[48:51], 0 offen offset:256 nt
    buffer_load_dwordx4 v[120:123], v58, s[48:51], 0 offen offset:2048 nt
    buffer_load_dwordx4 v[124:127], v58, s[48:51], 0 offen offset:2304 nt
    s_cmp_eq_u32 s82, 0
    s_cbranch_scc1 L_nopend1
    s_waitcnt lgkmcnt(0)
    s_sub_u32 s83, s83, s85
    s_min_u32 s83, s83, 0x4000
    s_lshr_b32 s12, s83, 5
    s_mul_i32 s12, s12, 128
    s_and_b32 s13, s83, 31
    s_lshl_b32 s13, s13, 2
    s_add_u32 s12, s12, s13
    s_add_u32 s12, s12, 6144
    s_lshl_b32 s13, s12, 19
    s_or_b32 s13, s13, 4096
    s_cmp_ge_u32 s12, 8192
    s_cselect_b32 s83, 0xfff80001, s13
    v_mov_b32 v56, s83
    ds_write_b32 v62, v56 offset:2052
    s_mov_b32 s82, 0
L_nopend1:
    s_branch L_loop
L_slow0:
    s_cmp_eq_u32 s12, 0x1fff
    s_cbranch_scc1 L_drain0
    s_cmp_eq_u32 s13, s6
    s_cbranch_scc1 L_inst0
    s_lshr_b32 s7, s14, 12
    s_mov_b32 s13, 4000000
L_retry0:
    s_sleep 1
    ds_read_b32 v56, v62 offset:2048
    s_waitcnt lgkmcnt(0)
    v_readfirstlane_b32 s12, v56
    s_lshr_b32 s12, s12, 12
    s_cmp_lg_u32 s12, s7
    s_cbranch_scc1 L_redraw0
    s_sub_u32 s13, s13, 1
    s_cmp_lg_u32 s13, 0
    s_cbranch_scc1 L_retry0
    s_branch L_drain0
L_redraw0:
    s_mov_b64 exec, 1
    ds_add_rtn_u32 v60, v62, v61 offset:2048
    s_mov_b64 exec, -1
    s_branch L_chk0
L_inst0:
    s_mov_b32 s13, 4000000
L_instw0:
    ds_read_b32 v56, v62 offset:2052
    s_waitcnt lgkmcnt(0)
    v_readfirstlane_b32 s12, v56
    s_cmp_lg_u32 s12, -1
    s_cbranch_scc1 L_instg0
    s_sleep 1
    s_sub_u32 s13, s13, 1
    s_cmp_lg_u32 s13, 0
    s_cbranch_scc1 L_instw0
    s_mov_b32 s12, 0xfff80001
L_instg0:
    s_cmp_eq_u32 s12, 0xfff80001
    s_cbranch_scc0 L_instv0
    v_mov_b32 v56, s12
    ds_write_b32 v62, v56 offset:2048
    s_branch L_drain0
L_instv0:
    v_mov_b32 v57, -1
    s_mov_b32 s83, 1
    s_atomic_add s83, s[42:43], s84 glc
    s_mov_b32 s82, 1
    ds_write_b32 v62, v57 offset:2052
    s_or_b32 s13, s12, 1
    v_mov_b32 v56, s13
    ds_write_b32 v62, v56 offset:2048
    s_lshr_b32 s12, s12, 19
    s_mov_b32 s13, 0
    s_branch L_ok0
L_slow1:
    s_cmp_eq_u32 s12, 0x1fff
    s_cbranch_scc1 L_drain1
    s_cmp_eq_u32 s13, s6
    s_cbranch_scc1 L_inst1
    s_lshr_b32 s7, s14, 12
    s_mov_b32 s13, 4000000
L_retry1:
    s_sleep 1
    ds_read_b32 v56, v62 offset:2048
    s_waitcnt lgkmcnt(0)
    v_readfirstlane_b32 s12, v56
    s_lshr_b32 s12, s12, 12
    s_cmp_lg_u32 s12, s7
    s_cbranch_scc1 L_redraw1
    s_sub_u32 s13, s13, 1
    s_cmp_lg_u32 s13, 0
    s_cbranch_scc1 L_retry1
    s_branch L_drain1
L_redraw1:
    s_mov_b64 exec, 1
    ds_add_rtn_u32 v60, v62, v61 offset:2048
    s_mov_b64 exec, -1
    s_branch L_chk1
L_inst1:
    s_mov_b32 s13, 4000000
L_instw1:
    ds_read_b32 v56, v62 offset:2052
    s_waitcnt lgkmcnt(0)
    v_readfirstlane_b32 s12, v56
    s_cmp_lg_u32 s12, -1
    s_cbranch_scc1 L_instg1
    s_sleep 1
    s_sub_u32 s13, s13, 1
    s_cmp_lg_u32 s13, 0
    s_cbranch_scc1 L_instw1
    s_mov_b32 s12, 0xfff80001
L_instg1:
    s_cmp_eq_u32 s12, 0xfff80001
    s_cbranch_scc0 L_instv1
    v_mov_b32 v56, s12
    ds_write_b32 v62, v56 offset:2048
    s_branch L_drain1
L_instv1:
    v_mov_b32 v57, -1
    s_mov_b32 s83, 1
    s_atomic_add s83, s[42:43], s84 glc
    s_mov_b32 s82, 1
    ds_write_b32 v62, v57 offset:2052
    s_or_b32 s13, s12, 1
    v_mov_b32 v56, s13
    ds_write_b32 v62, v56 offset:2048
    s_lshr_b32 s12, s12, 19
    s_mov_b32 s13, 0
    s_branch L_ok1
L_drain1:
    s_waitcnt vmcnt(0)
    v_dot2_f32_bf16 v36, v96, v16, 0
    v_dot2_f32_bf16 v37, v96, v24, 0
    v_dot2_f32_bf16 v38, v104, v16, 0
    v_dot2_f32_bf16 v39, v104, v24, 0
    v_dot2_f32_bf16 v36, v97, v17, v36
    v_dot2_f32_bf16 v37, v97, v25, v37
    v_dot2_f32_bf16 v38, v105, v17, v38
    v_dot2_f32_bf16 v39, v105, v25, v39
    v_dot2_f32_bf16 v36, v98, v18, v36
    v_dot2_f32_bf16 v37, v98, v26, v37
    v_dot2_f32_bf16 v38, v106, v18, v38
    v_dot2_f32_bf16 v39, v106, v26, v39
    v_dot2_f32_bf16 v36, v99, v19, v36
    v_dot2_f32_bf16 v37, v99, v27, v37
    v_dot2_f32_bf16 v38, v107, v19, v38
    v_dot2_f32_bf16 v39, v107, v27, v39
    v_dot2_f32_bf16 v36, v100, v20, v36
    v_dot2_f32_bf16 v37, v100, v28, v37
    v_dot2_f32_bf16 v38, v108, v20, v38
    v_dot2_f32_bf16 v39, v108, v28, v39
    v_dot2_f32_bf16 v36, v101, v21, v36
    v_dot2_f32_bf16 v37, v101, v29, v37
    v_dot2_f32_bf16 v38, v109, v21, v38
    v_dot2_f32_bf16 v39, v109, v29, v39
    v_dot2_f32_bf16 v36, v102, v22, v36
    v_dot2_f32_bf16 v37, v102, v30, v37
    v_dot2_f32_bf16 v38, v110, v22, v38
    v_dot2_f32_bf16 v39, v110, v30, v39
    v_dot2_f32_bf16 v36, v103, v23, v36
    v_dot2_f32_bf16 v37, v103, v31, v37
    v_dot2_f32_bf16 v38, v111, v23, v38
    v_dot2_f32_bf16 v39, v111, v31, v39
    s_nop 2
    v_add_f32_dpp v40, v36, v36 row_ror:8 row_mask:0xf bank_mask:0x3
    v_add_f32_dpp v41, v38, v38 row_ror:8 row_mask:0xf bank_mask:0x3
    v_add_f32_dpp v40, v37, v37 row_ror:8 row_mask:0xf bank_mask:0xc
    v_add_f32_dpp v41, v39, v39 row_ror:8 row_mask:0xf bank_mask:0xc
    s_nop 0
    v_add_f32_dpp v40, v40, v40 row_half_mirror row_mask:0xf bank_mask:0xf
    v_add_f32_dpp v41, v41, v41 row_half_mirror row_mask:0xf bank_mask:0xf
    s_nop 0
    v_add_f32_dpp v40, v40, v40 quad_perm:[1,0,3,2] row_mask:0xf bank_mask:0xf
    v_add_f32_dpp v41, v41, v41 quad_perm:[1,0,3,2] row_mask:0xf bank_mask:0xf
    s_nop 0
    v_add_f32_dpp v40, v40, v40 quad_perm:[2,3,0,1] row_mask:0xf bank_mask:0xf
    v_add_f32_dpp v41, v41, v41 quad_perm:[2,3,0,1] row_mask:0xf bank_mask:0xf
    v_cvt_pk_bf16_f32 v42, v40, v41
    v_lshlrev_b32 v43, 16, v42
    v_and_b32 v44, 0xffff0000, v42
    v_max_f32 v45, v43, v44
    v_cmp_gt_f32 vcc, v45, v33
    s_cbranch_vccz L_nomaxd1
    v_max_f32 v45, v45, v33
    v_mov_b32 v56, v45
    s_nop 1
    v_permlane32_swap_b32 v45, v56
    v_max_f32 v45, v45, v56
    v_mov_b32 v56, v45
    s_nop 1
    v_permlane16_swap_b32 v45, v56
    v_max_f32 v45, v45, v56
    v_sub_f32 v57, v33, v45
    v_mul_f32 v57, s9, v57
    v_exp_f32 v57, v57
    v_mov_b32 v33, v45
    v_mul_f32 v34, s9, v45
    v_mul_f32 v35, v35, v57
    v_mov_b32 v32, v57
    s_nop 1
    v_mov_b32_dpp v32, v57 row_ror:8 row_mask:0x3 bank_mask:0xc
    v_mov_b32_dpp v32, v57 row_ror:8 row_mask:0xc bank_mask:0x3
    v_mul_f32 v8, v8, v32
    v_mul_f32 v9, v9, v32
    v_mul_f32 v10, v10, v32
    v_mul_f32 v11, v11, v32
    v_mul_f32 v12, v12, v32
    v_mul_f32 v13, v13, v32
    v_mul_f32 v14, v14, v32
    v_mul_f32 v15, v15, v32
L_nomaxd1:
    v_fma_f32 v46, v43, s9, -v34
    v_fma_f32 v47, v44, s9, -v34
    v_exp_f32 v46, v46
    v_exp_f32 v47, v47
    s_nop 0
    v_cvt_pk_bf16_f32 v56, v46, v46
    v_cvt_pk_bf16_f32 v57, v47, v47
    v_and_b32 v48, v56, v4
    v_and_b32 v49, v56, v5
    v_and_b32 v50, v56, v6
    v_and_b32 v51, v56, v7
    v_and_b32 v52, v57, v4
    v_and_b32 v53, v57, v5
    v_and_b32 v54, v57, v6
    v_and_b32 v55, v57, v7
    v_add_f32 v35, v35, v46
    v_add_f32 v35, v35, v47
    s_nop 0
    v_mfma_f32_16x16x32_bf16 v[8:11], v[48:51], v[112:115], v[8:11]
    v_mfma_f32_16x16x32_bf16 v[12:15], v[48:51], v[116:119], v[12:15]
    v_mfma_f32_16x16x32_bf16 v[8:11], v[52:55], v[120:123], v[8:11]
    v_mfma_f32_16x16x32_bf16 v[12:15], v[52:55], v[124:127], v[12:15]
L_drainj1:
    s_waitcnt vmcnt(0)
    v_dot2_f32_bf16 v36, v64, v16, 0
    v_dot2_f32_bf16 v37, v64, v24, 0
    v_dot2_f32_bf16 v38, v72, v16, 0
    v_dot2_f32_bf16 v39, v72, v24, 0
    v_dot2_f32_bf16 v36, v65, v17, v36
    v_dot2_f32_bf16 v37, v65, v25, v37
    v_dot2_f32_bf16 v38, v73, v17, v38
    v_dot2_f32_bf16 v39, v73, v25, v39
    v_dot2_f32_bf16 v36, v66, v18, v36
    v_dot2_f32_bf16 v37, v66, v26, v37
    v_dot2_f32_bf16 v38, v74, v18, v38
    v_dot2_f32_bf16 v39, v74, v26, v39
    v_dot2_f32_bf16 v36, v67, v19, v36
    v_dot2_f32_bf16 v37, v67, v27, v37
    v_dot2_f32_bf16 v38, v75, v19, v38
    v_dot2_f32_bf16 v39, v75, v27, v39
    v_dot2_f32_bf16 v36, v68, v20, v36
    v_dot2_f32_bf16 v37, v68, v28, v37
    v_dot2_f32_bf16 v38, v76, v20, v38
    v_dot2_f32_bf16 v39, v76, v28, v39
    v_dot2_f32_bf16 v36, v69, v21, v36
    v_dot2_f32_bf16 v37, v69, v29, v37
    v_dot2_f32_bf16 v38, v77, v21, v38
    v_dot2_f32_bf16 v39, v77, v29, v39
    v_dot2_f32_bf16 v36, v70, v22, v36
    v_dot2_f32_bf16 v37, v70, v30, v37
    v_dot2_f32_bf16 v38, v78, v22, v38
    v_dot2_f32_bf16 v39, v78, v30, v39
    v_dot2_f32_bf16 v36, v71, v23, v36
    v_dot2_f32_bf16 v37, v71, v31, v37
    v_dot2_f32_bf16 v38, v79, v23, v38
    v_dot2_f32_bf16 v39, v79, v31, v39
    s_nop 2
    v_add_f32_dpp v40, v36, v36 row_ror:8 row_mask:0xf bank_mask:0x3
    v_add_f32_dpp v41, v38, v38 row_ror:8 row_mask:0xf bank_mask:0x3
    v_add_f32_dpp v40, v37, v37 row_ror:8 row_mask:0xf bank_mask:0xc
    v_add_f32_dpp v41, v39, v39 row_ror:8 row_mask:0xf bank_mask:0xc
    s_nop 0
    v_add_f32_dpp v40, v40, v40 row_half_mirror row_mask:0xf bank_mask:0xf
    v_add_f32_dpp v41, v41, v41 row_half_mirror row_mask:0xf bank_mask:0xf
    s_nop 0
    v_add_f32_dpp v40, v40, v40 quad_perm:[1,0,3,2] row_mask:0xf bank_mask:0xf
    v_add_f32_dpp v41, v41, v41 quad_perm:[1,0,3,2] row_mask:0xf bank_mask:0xf
    s_nop 0
    v_add_f32_dpp v40, v40, v40 quad_perm:[2,3,0,1] row_mask:0xf bank_mask:0xf
    v_add_f32_dpp v41, v41, v41 quad_perm:[2,3,0,1] row_mask:0xf bank_mask:0xf
    v_cvt_pk_bf16_f32 v42, v40, v41
    v_lshlrev_b32 v43, 16, v42
    v_and_b32 v44, 0xffff0000, v42
    v_max_f32 v45, v43, v44
    v_cmp_gt_f32 vcc, v45, v33
    s_cbranch_vccz L_nomaxd1b
    v_max_f32 v45, v45, v33
    v_mov_b32 v56, v45
    s_nop 1
    v_permlane32_swap_b32 v45, v56
    v_max_f32 v45, v45, v56
    v_mov_b32 v56, v45
    s_nop 1
    v_permlane16_swap_b32 v45, v56
    v_max_f32 v45, v45, v56
    v_sub_f32 v57, v33, v45
    v_mul_f32 v57, s9, v57
    v_exp_f32 v57, v57
    v_mov_b32 v33, v45
    v_mul_f32 v34, s9, v45
    v_mul_f32 v35, v35, v57
    v_mov_b32 v32, v57
    s_nop 1
    v_mov_b32_dpp v32, v57 row_ror:8 row_mask:0x3 bank_mask:0xc
    v_mov_b32_dpp v32, v57 row_ror:8 row_mask:0xc bank_mask:0x3
    v_mul_f32 v8, v8, v32
    v_mul_f32 v9, v9, v32
    v_mul_f32 v10, v10, v32
    v_mul_f32 v11, v11, v32
    v_mul_f32 v12, v12, v32
    v_mul_f32 v13, v13, v32
    v_mul_f32 v14, v14, v32
    v_mul_f32 v15, v15, v32
L_nomaxd1b:
    v_fma_f32 v46, v43, s9, -v34
    v_fma_f32 v47, v44, s9, -v34
    v_exp_f32 v46, v46
    v_exp_f32 v47, v47
    s_nop 0
    v_cvt_pk_bf16_f32 v56, v46, v46
    v_cvt_pk_bf16_f32 v57, v47, v47
    v_and_b32 v48, v56, v4
    v_and_b32 v49, v56, v5
    v_and_b32 v50, v56, v6
    v_and_b32 v51, v56, v7
    v_and_b32 v52, v57, v4
    v_and_b32 v53, v57, v5
    v_and_b32 v54, v57, v6
    v_and_b32 v55, v57, v7
    v_add_f32 v35, v35, v46
    v_add_f32 v35, v35, v47
    s_nop 0
    v_mfma_f32_16x16x32_bf16 v[8:11], v[48:51], v[80:83], v[8:11]
    v_mfma_f32_16x16x32_bf16 v[12:15], v[48:51], v[84:87], v[12:15]
    v_mfma_f32_16x16x32_bf16 v[8:11], v[52:55], v[88:91], v[8:11]
    v_mfma_f32_16x16x32_bf16 v[12:15], v[52:55], v[92:95], v[12:15]
    s_branch L_drained
L_drain0:
    s_waitcnt vmcnt(0)
    v_dot2_f32_bf16 v36, v64, v16, 0
    v_dot2_f32_bf16 v37, v64, v24, 0
    v_dot2_f32_bf16 v38, v72, v16, 0
    v_dot2_f32_bf16 v39, v72, v24, 0
    v_dot2_f32_bf16 v36, v65, v17, v36
    v_dot2_f32_bf16 v37, v65, v25, v37
    v_dot2_f32_bf16 v38, v73, v17, v38
    v_dot2_f32_bf16 v39, v73, v25, v39
    v_dot2_f32_bf16 v36, v66, v18, v36
    v_dot2_f32_bf16 v37, v66, v26, v37
    v_dot2_f32_bf16 v38, v74, v18, v38
    v_dot2_f32_bf16 v39, v74, v26, v39
    v_dot2_f32_bf16 v36, v67, v19, v36
    v_dot2_f32_bf16 v37, v67, v27, v37
    v_dot2_f32_bf16 v38, v75, v19, v38
    v_dot2_f32_bf16 v39, v75, v27, v39
    v_dot2_f32_bf16 v36, v68, v20, v36
    v_dot2_f32_bf16 v37, v68, v28, v37
    v_dot2_f32_bf16 v38, v76, v20, v38
    v_dot2_f32_bf16 v39, v76, v28, v39
    v_dot2_f32_bf16 v36, v69, v21, v36
    v_dot2_f32_bf16 v37, v69, v29, v37
    v_dot2_f32_bf16 v38, v77, v21, v38
    v_dot2_f32_bf16 v39, v77, v29, v39
    v_dot2_f32_bf16 v36, v70, v22, v36
    v_dot2_f32_bf16 v37, v70, v30, v37
    v_dot2_f32_bf16 v38, v78, v22, v38
    v_dot2_f32_bf16 v39, v78, v30, v39
    v_dot2_f32_bf16 v36, v71, v23, v36
    v_dot2_f32_bf16 v37, v71, v31, v37
    v_dot2_f32_bf16 v38, v79, v23, v38
    v_dot2_f32_bf16 v39, v79, v31, v39
    s_nop 2
    v_add_f32_dpp v40, v36, v36 row_ror:8 row_mask:0xf bank_mask:0x3
    v_add_f32_dpp v41, v38, v38 row_ror:8 row_mask:0xf bank_mask:0x3
    v_add_f32_dpp v40, v37, v37 row_ror:8 row_mask:0xf bank_mask:0xc
    v_add_f32_dpp v41, v39, v39 row_ror:8 row_mask:0xf bank_mask:0xc
    s_nop 0
    v_add_f32_dpp v40, v40, v40 row_half_mirror row_mask:0xf bank_mask:0xf
    v_add_f32_dpp v41, v41, v41 row_half_mirror row_mask:0xf bank_mask:0xf
    s_nop 0
    v_add_f32_dpp v40, v40, v40 quad_perm:[1,0,3,2] row_mask:0xf bank_mask:0xf
    v_add_f32_dpp v41, v41, v41 quad_perm:[1,0,3,2] row_mask:0xf bank_mask:0xf
    s_nop 0
    v_add_f32_dpp v40, v40, v40 quad_perm:[2,3,0,1] row_mask:0xf bank_mask:0xf
    v_add_f32_dpp v41, v41, v41 quad_perm:[2,3,0,1] row_mask:0xf bank_mask:0xf
    v_cvt_pk_bf16_f32 v42, v40, v41
    v_lshlrev_b32 v43, 16, v42
    v_and_b32 v44, 0xffff0000, v42
    v_max_f32 v45, v43, v44
    v_cmp_gt_f32 vcc, v45, v33
    s_cbranch_vccz L_nomaxd0
    v_max_f32 v45, v45, v33
    v_mov_b32 v56, v45
    s_nop 1
    v_permlane32_swap_b32 v45, v56
    v_max_f32 v45, v45, v56
    v_mov_b32 v56, v45
    s_nop 1
    v_permlane16_swap_b32 v45, v56
    v_max_f32 v45, v45, v56
    v_sub_f32 v57, v33, v45
    v_mul_f32 v57, s9, v57
    v_exp_f32 v57, v57
    v_mov_b32 v33, v45
    v_mul_f32 v34, s9, v45
    v_mul_f32 v35, v35, v57
    v_mov_b32 v32, v57
    s_nop 1
    v_mov_b32_dpp v32, v57 row_ror:8 row_mask:0x3 bank_mask:0xc
    v_mov_b32_dpp v32, v57 row_ror:8 row_mask:0xc bank_mask:0x3
    v_mul_f32 v8, v8, v32
    v_mul_f32 v9, v9, v32
    v_mul_f32 v10, v10, v32
    v_mul_f32 v11, v11, v32
    v_mul_f32 v12, v12, v32
    v_mul_f32 v13, v13, v32
    v_mul_f32 v14, v14, v32
    v_mul_f32 v15, v15, v32
L_nomaxd0:
    v_fma_f32 v46, v43, s9, -v34
    v_fma_f32 v47, v44, s9, -v34
    v_exp_f32 v46, v46
    v_exp_f32 v47, v47
    s_nop 0
    v_cvt_pk_bf16_f32 v56, v46, v46
    v_cvt_pk_bf16_f32 v57, v47, v47
    v_and_b32 v48, v56, v4
    v_and_b32 v49, v56, v5
    v_and_b32 v50, v56, v6
    v_and_b32 v51, v56, v7
    v_and_b32 v52, v57, v4
    v_and_b32 v53, v57, v5
    v_and_b32 v54, v57, v6
    v_and_b32 v55, v57, v7
    v_add_f32 v35, v35, v46
    v_add_f32 v35, v35, v47
    s_nop 0
    v_mfma_f32_16x16x32_bf16 v[8:11], v[48:51], v[80:83], v[8:11]
    v_mfma_f32_16x16x32_bf16 v[12:15], v[48:51], v[84:87], v[12:15]
    v_mfma_f32_16x16x32_bf16 v[8:11], v[52:55], v[88:91], v[8:11]
    v_mfma_f32_16x16x32_bf16 v[12:15], v[52:55], v[92:95], v[12:15]
    s_waitcnt vmcnt(0)
    v_dot2_f32_bf16 v36, v96, v16, 0
    v_dot2_f32_bf16 v37, v96, v24, 0
    v_dot2_f32_bf16 v38, v104, v16, 0
    v_dot2_f32_bf16 v39, v104, v24, 0
    v_dot2_f32_bf16 v36, v97, v17, v36
    v_dot2_f32_bf16 v37, v97, v25, v37
    v_dot2_f32_bf16 v38, v105, v17, v38
    v_dot2_f32_bf16 v39, v105, v25, v39
    v_dot2_f32_bf16 v36, v98, v18, v36
    v_dot2_f32_bf16 v37, v98, v26, v37
    v_dot2_f32_bf16 v38, v106, v18, v38
    v_dot2_f32_bf16 v39, v106, v26, v39
    v_dot2_f32_bf16 v36, v99, v19, v36
    v_dot2_f32_bf16 v37, v99, v27, v37
    v_dot2_f32_bf16 v38, v107, v19, v38
    v_dot2_f32_bf16 v39, v107, v27, v39
    v_dot2_f32_bf16 v36, v100, v20, v36
    v_dot2_f32_bf16 v37, v100, v28, v37
    v_dot2_f32_bf16 v38, v108, v20, v38
    v_dot2_f32_bf16 v39, v108, v28, v39
    v_dot2_f32_bf16 v36, v101, v21, v36
    v_dot2_f32_bf16 v37, v101, v29, v37
    v_dot2_f32_bf16 v38, v109, v21, v38
    v_dot2_f32_bf16 v39, v109, v29, v39
    v_dot2_f32_bf16 v36, v102, v22, v36
    v_dot2_f32_bf16 v37, v102, v30, v37
    v_dot2_f32_bf16 v38, v110, v22, v38
    v_dot2_f32_bf16 v39, v110, v30, v39
    v_dot2_f32_bf16 v36, v103, v23, v36
    v_dot2_f32_bf16 v37, v103, v31, v37
    v_dot2_f32_bf16 v38, v111, v23, v38
    v_dot2_f32_bf16 v39, v111, v31, v39
    s_nop 2
    v_add_f32_dpp v40, v36, v36 row_ror:8 row_mask:0xf bank_mask:0x3
    v_add_f32_dpp v41, v38, v38 row_ror:8 row_mask:0xf bank_mask:0x3
    v_add_f32_dpp v40, v37, v37 row_ror:8 row_mask:0xf bank_mask:0xc
    v_add_f32_dpp v41, v39, v39 row_ror:8 row_mask:0xf bank_mask:0xc
    s_nop 0
    v_add_f32_dpp v40, v40, v40 row_half_mirror row_mask:0xf bank_mask:0xf
    v_add_f32_dpp v41, v41, v41 row_half_mirror row_mask:0xf bank_mask:0xf
    s_nop 0
    v_add_f32_dpp v40, v40, v40 quad_perm:[1,0,3,2] row_mask:0xf bank_mask:0xf
    v_add_f32_dpp v41, v41, v41 quad_perm:[1,0,3,2] row_mask:0xf bank_mask:0xf
    s_nop 0
    v_add_f32_dpp v40, v40, v40 quad_perm:[2,3,0,1] row_mask:0xf bank_mask:0xf
    v_add_f32_dpp v41, v41, v41 quad_perm:[2,3,0,1] row_mask:0xf bank_mask:0xf
    v_cvt_pk_bf16_f32 v42, v40, v41
    v_lshlrev_b32 v43, 16, v42
    v_and_b32 v44, 0xffff0000, v42
    v_max_f32 v45, v43, v44
    v_cmp_gt_f32 vcc, v45, v33
    s_cbranch_vccz L_nomaxd0b
    v_max_f32 v45, v45, v33
    v_mov_b32 v56, v45
    s_nop 1
    v_permlane32_swap_b32 v45, v56
    v_max_f32 v45, v45, v56
    v_mov_b32 v56, v45
    s_nop 1
    v_permlane16_swap_b32 v45, v56
    v_max_f32 v45, v45, v56
    v_sub_f32 v57, v33, v45
    v_mul_f32 v57, s9, v57
    v_exp_f32 v57, v57
    v_mov_b32 v33, v45
    v_mul_f32 v34, s9, v45
    v_mul_f32 v35, v35, v57
    v_mov_b32 v32, v57
    s_nop 1
    v_mov_b32_dpp v32, v57 row_ror:8 row_mask:0x3 bank_mask:0xc
    v_mov_b32_dpp v32, v57 row_ror:8 row_mask:0xc bank_mask:0x3
    v_mul_f32 v8, v8, v32
    v_mul_f32 v9, v9, v32
    v_mul_f32 v10, v10, v32
    v_mul_f32 v11, v11, v32
    v_mul_f32 v12, v12, v32
    v_mul_f32 v13, v13, v32
    v_mul_f32 v14, v14, v32
    v_mul_f32 v15, v15, v32
L_nomaxd0b:
    v_fma_f32 v46, v43, s9, -v34
    v_fma_f32 v47, v44, s9, -v34
    v_exp_f32 v46, v46
    v_exp_f32 v47, v47
    s_nop 0
    v_cvt_pk_bf16_f32 v56, v46, v46
    v_cvt_pk_bf16_f32 v57, v47, v47
    v_and_b32 v48, v56, v4
    v_and_b32 v49, v56, v5
    v_and_b32 v50, v56, v6
    v_and_b32 v51, v56, v7
    v_and_b32 v52, v57, v4
    v_and_b32 v53, v57, v5
    v_and_b32 v54, v57, v6
    v_and_b32 v55, v57, v7
    v_add_f32 v35, v35, v46
    v_add_f32 v35, v35, v47
    s_nop 0
    v_mfma_f32_16x16x32_bf16 v[8:11], v[48:51], v[112:115], v[8:11]
    v_mfma_f32_16x16x32_bf16 v[12:15], v[48:51], v[116:119], v[12:15]
    v_mfma_f32_16x16x32_bf16 v[8:11], v[52:55], v[120:123], v[8:11]
    v_mfma_f32_16x16x32_bf16 v[12:15], v[52:55], v[124:127], v[12:15]
L_drained:
L_loopend:
    v_mov_b32 v56, v35
    s_nop 1
    v_permlane32_swap_b32 v35, v56
    v_add_f32 v35, v35, v56
    v_mov_b32 v56, v35
    s_nop 1
    v_permlane16_swap_b32 v35, v56
    v_add_f32 v35, v35, v56
    v_lshrrev_b32 v57, 5, v2
    v_lshlrev_b32 v57, 10, v57
    v_lshl_add_u32 v57, v3, 5, v57
    v_and_b32 v32, 1, v1
    v_lshl_add_u32 v57, v32, 4, v57
    s_lshl_b32 s12, s3, 11
    v_add_u32 v57, s12, v57
    ds_write_b128 v57, v[8:11] offset:19456
    ds_write_b128 v57, v[12:15] offset:19968
    v_mul_u32_u24 v57, 16, v2
    s_lshr_b32 s12, s3, 0
    s_mul_i32 s13, s88, 32
    s_add_u32 s12, s12, s13
    s_lshl_b32 s12, s12, 3
    v_add_u32 v57, s12, v57
    s_mov_b64 exec, 0x101
    ds_write_b64 v57, v[34:35] offset:2176
    s_mov_b64 exec, -1
    s_cmp_lt_u32 s3, 2
    s_cbranch_scc1 L_nomerge
    v_mov_b32 v62, 0
    s_waitcnt lgkmcnt(0)
    s_mov_b64 exec, 1
    ds_add_rtn_u32 v60, v62, v61 offset:2100
    s_mov_b64 exec, -1
    s_waitcnt lgkmcnt(0)
    v_readfirstlane_b32 s12, v60
    s_cmp_lg_u32 s12, 13
    s_cbranch_scc1 L_nomerge
    v_lshrrev_b32 v60, 5, v2
    v_lshlrev_b32 v60, 7, v60
    v_lshlrev_b32 v62, 5, v2
    ds_read_b128 v[16:19], v60 offset:2176
    ds_read_b128 v[20:23], v60 offset:2192
    ds_read_b128 v[24:27], v60 offset:2208
    ds_read_b128 v[28:31], v60 offset:2224
    ds_read_b128 v[32:35], v60 offset:2240
    ds_read_b128 v[36:39], v60 offset:2256
    ds_read_b128 v[40:43], v60 offset:2272
    ds_read_b128 v[44:47], v60 offset:2288
    s_waitcnt lgkmcnt(0)
    v_mov_b32 v48, v20
    v_max_f32 v48, v48, v22
    v_max_f32 v48, v48, v24
    v_max_f32 v48, v48, v26
    v_max_f32 v48, v48, v28
    v_max_f32 v48, v48, v30
    v_max_f32 v48, v48, v32
    v_max_f32 v48, v48, v34
    v_max_f32 v48, v48, v36
    v_max_f32 v48, v48, v38
    v_max_f32 v48, v48, v40
    v_max_f32 v48, v48, v42
    v_max_f32 v48, v48, v44
    v_max_f32 v48, v48, v46
    v_sub_f32 v20, v20, v48
    v_sub_f32 v22, v22, v48
    v_sub_f32 v24, v24, v48
    v_sub_f32 v26, v26, v48
    v_sub_f32 v28, v28, v48
    v_sub_f32 v30, v30, v48
    v_sub_f32 v32, v32, v48
    v_sub_f32 v34, v34, v48
    v_sub_f32 v36, v36, v48
    v_sub_f32 v38, v38, v48
    v_sub_f32 v40, v40, v48
    v_sub_f32 v42, v42, v48
    v_sub_f32 v44, v44, v48
    v_sub_f32 v46, v46, v48
    v_exp_f32 v20, v20
    v_exp_f32 v22, v22
    v_exp_f32 v24, v24
    v_exp_f32 v26, v26
    v_exp_f32 v28, v28
    v_exp_f32 v30, v30
    v_exp_f32 v32, v32
    v_exp_f32 v34, v34
    v_exp_f32 v36, v36
    v_exp_f32 v38, v38
    v_exp_f32 v40, v40
    v_exp_f32 v42, v42
    v_exp_f32 v44, v44
    v_exp_f32 v46, v46
    s_nop 0
    v_mul_f32 v49, v20, v21
    v_fmac_f32 v49, v22, v23
    v_fmac_f32 v49, v24, v25
    v_fmac_f32 v49, v26, v27
    v_fmac_f32 v49, v28, v29
    v_fmac_f32 v49, v30, v31
    v_fmac_f32 v49, v32, v33
    v_fmac_f32 v49, v34, v35
    v_fmac_f32 v49, v36, v37
    v_fmac_f32 v49, v38, v39
    v_fmac_f32 v49, v40, v41
    v_fmac_f32 v49, v42, v43
    v_fmac_f32 v49, v44, v45
    v_fmac_f32 v49, v46, v47
    ds_read_b128 v[64:67], v62 offset:23552
    ds_read_b128 v[68:71], v62 offset:25600
    ds_read_b128 v[72:75], v62 offset:27648
    ds_read_b128 v[76:79], v62 offset:29696
    ds_read_b128 v[80:83], v62 offset:31744
    ds_read_b128 v[84:87], v62 offset:33792
    ds_read_b128 v[88:91], v62 offset:35840
    ds_read_b128 v[92:95], v62 offset:37888
    ds_read_b128 v[96:99], v62 offset:39936
    ds_read_b128 v[100:103], v62 offset:41984
    ds_read_b128 v[104:107], v62 offset:44032
    ds_read_b128 v[108:111], v62 offset:46080
    ds_read_b128 v[112:115], v62 offset:48128
    ds_read_b128 v[116:119], v62 offset:50176
    s_waitcnt lgkmcnt(0)
    v_mul_f32 v52, v20, v64
    v_mul_f32 v53, v20, v65
    v_mul_f32 v54, v20, v66
    v_mul_f32 v55, v20, v67
    v_fmac_f32 v52, v22, v68
    v_fmac_f32 v53, v22, v69
    v_fmac_f32 v54, v22, v70
    v_fmac_f32 v55, v22, v71
    v_fmac_f32 v52, v24, v72
    v_fmac_f32 v53, v24, v73
    v_fmac_f32 v54, v24, v74
    v_fmac_f32 v55, v24, v75
    v_fmac_f32 v52, v26, v76
    v_fmac_f32 v53, v26, v77
    v_fmac_f32 v54, v26, v78
    v_fmac_f32 v55, v26, v79
    v_fmac_f32 v52, v28, v80
    v_fmac_f32 v53, v28, v81
    v_fmac_f32 v54, v28, v82
    v_fmac_f32 v55, v28, v83
    v_fmac_f32 v52, v30, v84
    v_fmac_f32 v53, v30, v85
    v_fmac_f32 v54, v30, v86
    v_fmac_f32 v55, v30, v87
    v_fmac_f32 v52, v32, v88
    v_fmac_f32 v53, v32, v89
    v_fmac_f32 v54, v32, v90
    v_fmac_f32 v55, v32, v91
    v_fmac_f32 v52, v34, v92
    v_fmac_f32 v53, v34, v93
    v_fmac_f32 v54, v34, v94
    v_fmac_f32 v55, v34, v95
    v_fmac_f32 v52, v36, v96
    v_fmac_f32 v53, v36, v97
    v_fmac_f32 v54, v36, v98
    v_fmac_f32 v55, v36, v99
    v_fmac_f32 v52, v38, v100
    v_fmac_f32 v53, v38, v101
    v_fmac_f32 v54, v38, v102
    v_fmac_f32 v55, v38, v103
    v_fmac_f32 v52, v40, v104
    v_fmac_f32 v53, v40, v105
    v_fmac_f32 v54, v40, v106
    v_fmac_f32 v55, v40, v107
    v_fmac_f32 v52, v42, v108
    v_fmac_f32 v53, v42, v109
    v_fmac_f32 v54, v42, v110
    v_fmac_f32 v55, v42, v111
    v_fmac_f32 v52, v44, v112
    v_fmac_f32 v53, v44, v113
    v_fmac_f32 v54, v44, v114
    v_fmac_f32 v55, v44, v115
    v_fmac_f32 v52, v46, v116
    v_fmac_f32 v53, v46, v117
    v_fmac_f32 v54, v46, v118
    v_fmac_f32 v55, v46, v119
    ds_read_b128 v[64:67], v62 offset:23568
    ds_read_b128 v[68:71], v62 offset:25616
    ds_read_b128 v[72:75], v62 offset:27664
    ds_read_b128 v[76:79], v62 offset:29712
    ds_read_b128 v[80:83], v62 offset:31760
    ds_read_b128 v[84:87], v62 offset:33808
    ds_read_b128 v[88:91], v62 offset:35856
    ds_read_b128 v[92:95], v62 offset:37904
    ds_read_b128 v[96:99], v62 offset:39952
    ds_read_b128 v[100:103], v62 offset:42000
    ds_read_b128 v[104:107], v62 offset:44048
    ds_read_b128 v[108:111], v62 offset:46096
    ds_read_b128 v[112:115], v62 offset:48144
    ds_read_b128 v[116:119], v62 offset:50192
    s_waitcnt lgkmcnt(0)
    v_mul_f32 v56, v20, v64
    v_mul_f32 v57, v20, v65
    v_mul_f32 v58, v20, v66
    v_mul_f32 v59, v20, v67
    v_fmac_f32 v56, v22, v68
    v_fmac_f32 v57, v22, v69
    v_fmac_f32 v58, v22, v70
    v_fmac_f32 v59, v22, v71
    v_fmac_f32 v56, v24, v72
    v_fmac_f32 v57, v24, v73
    v_fmac_f32 v58, v24, v74
    v_fmac_f32 v59, v24, v75
    v_fmac_f32 v56, v26, v76
    v_fmac_f32 v57, v26, v77
    v_fmac_f32 v58, v26, v78
    v_fmac_f32 v59, v26, v79
    v_fmac_f32 v56, v28, v80
    v_fmac_f32 v57, v28, v81
    v_fmac_f32 v58, v28, v82
    v_fmac_f32 v59, v28, v83
    v_fmac_f32 v56, v30, v84
    v_fmac_f32 v57, v30, v85
    v_fmac_f32 v58, v30, v86
    v_fmac_f32 v59, v30, v87
    v_fmac_f32 v56, v32, v88
    v_fmac_f32 v57, v32, v89
    v_fmac_f32 v58, v32, v90
    v_fmac_f32 v59, v32, v91
    v_fmac_f32 v56, v34, v92
    v_fmac_f32 v57, v34, v93
    v_fmac_f32 v58, v34, v94
    v_fmac_f32 v59, v34, v95
    v_fmac_f32 v56, v36, v96
    v_fmac_f32 v57, v36, v97
    v_fmac_f32 v58, v36, v98
    v_fmac_f32 v59, v36, v99
    v_fmac_f32 v56, v38, v100
    v_fmac_f32 v57, v38, v101
    v_fmac_f32 v58, v38, v102
    v_fmac_f32 v59, v38, v103
    v_fmac_f32 v56, v40, v104
    v_fmac_f32 v57, v40, v105
    v_fmac_f32 v58, v40, v106
    v_fmac_f32 v59, v40, v107
    v_fmac_f32 v56, v42, v108
    v_fmac_f32 v57, v42, v109
    v_fmac_f32 v58, v42, v110
    v_fmac_f32 v59, v42, v111
    v_fmac_f32 v56, v44, v112
    v_fmac_f32 v57, v44, v113
    v_fmac_f32 v58, v44, v114
    v_fmac_f32 v59, v44, v115
    v_fmac_f32 v56, v46, v116
    v_fmac_f32 v57, v46, v117
    v_fmac_f32 v58, v46, v118
    v_fmac_f32 v59, v46, v119
    ds_write_b128 v62, v[52:55] offset:23552
    ds_write_b128 v62, v[56:59] offset:23568
    s_mov_b32 exec_lo, 1
    s_mov_b32 exec_hi, 1
    ds_write_b64 v60, v[48:49] offset:2192
    s_mov_b64 exec, -1
L_nomerge:
    s_lshr_b32 s7, s3, 3
    s_mul_i32 s12, s7, 8
    s_add_u32 s12, s12, s4
    s_lshl_b32 s12, s12, 5
    s_add_u32 s12, s12, s5
    s_lshl_b32 s12, s12, 13
    s_add_u32 s60, s42, s12
    s_addc_u32 s61, s43, 0
    v_lshrrev_b32 v60, 8, v0
    v_mul_u32_u24 v60, 128, v60
    v_and_b32 v63, 511, v0
    s_lshl_b32 s13, s7, 11
    v_lshlrev_b32 v62, 2, v63
    v_add_u32 v62, s13, v62
    v_mov_b32 v45, s10
    v_mov_b32 v41, s10
    v_mov_b32 v43, s10
    s_waitcnt vmcnt(0) lgkmcnt(0)
    s_barrier
    s_cmp_ge_u32 s3, 8
    s_cbranch_scc1 L_t3_check
    ds_read_b128 v[64:67], v60 offset:2176
    ds_read_b128 v[68:71], v60 offset:2192
    ds_read_b32 v96, v62 offset:19456
    ds_read_b32 v97, v62 offset:21504
    ds_read_b32 v98, v62 offset:23552
    v_lshlrev_b32 v62, 3, v63
    s_waitcnt lgkmcnt(3)
    v_max3_f32 v40, v64, v66, v68
    v_sub_f32 v64, v64, v40
    v_sub_f32 v66, v66, v40
    v_sub_f32 v68, v68, v40
    v_exp_f32 v64, v64
    v_exp_f32 v66, v66
    v_exp_f32 v68, v68
    s_waitcnt lgkmcnt(0)
    v_mul_f32 v44, v64, v96
    v_fmac_f32 v44, v66, v97
    v_fmac_f32 v44, v68, v98
    v_mov_b32 v47, s10
    s_nop 0
    v_mov_b32_dpp v46, v44 quad_perm:[1,1,3,3] row_mask:0xf bank_mask:0xf
    s_mov_b32 exec_lo, 0x55555555
    s_mov_b32 exec_hi, 0x55555555
    global_store_dwordx4 v62, v[44:47], s[60:61] sc1
    s_mov_b64 exec, -1
    v_mul_f32 v42, v64, v65
    v_fmac_f32 v42, v66, v67
    v_fmac_f32 v42, v68, v69
    v_and_b32 v62, 255, v0
    v_lshrrev_b32 v60, 4, v63
    v_add_u32 v60, 0x1000, v60
    v_cmp_eq_u32 vcc, 0, v62
    s_and_saveexec_b64 s[62:63], vcc
    s_cbranch_execz L_t1_noml
    global_store_dwordx4 v60, v[40:43], s[60:61] sc1
L_t1_noml:
    s_mov_b64 exec, s[62:63]
    s_cmp_lg_u32 s3, 0
    s_cbranch_scc1 L_t3_check
    v_mul_u32_u24 v60, 896, v1
    v_lshl_add_u32 v60, v3, 4, v60
    ds_read_b128 v[64:67], v60 offset:4736
    ds_read_b128 v[68:71], v60 offset:4992
    ds_read_b128 v[72:75], v60 offset:5248
    ds_read_b128 v[76:79], v60 offset:5504
    ds_read_b128 v[80:83], v60 offset:8320
    ds_read_b128 v[84:87], v60 offset:8576
    ds_read_b128 v[88:91], v60 offset:8832
    ds_read_b128 v[92:95], v60 offset:9088
    ds_read_b128 v[96:99], v60 offset:11904
    ds_read_b128 v[100:103], v60 offset:12160
    ds_read_b128 v[104:107], v60 offset:12416
    ds_read_b128 v[108:111], v60 offset:12672
    ds_read_b128 v[112:115], v60 offset:15488
    ds_read_b128 v[116:119], v60 offset:15744
    ds_read_b128 v[120:123], v60 offset:16000
    ds_read_b128 v[124:127], v60 offset:16256
    v_lshrrev_b32 v61, 3, v2
    v_lshlrev_b32 v60, 15, v61
    v_and_b32 v63, 7, v2
    v_lshl_add_u32 v60, v63, 4, v60
    s_lshl_b32 s13, s86, 18
    s_lshl_b32 s14, s87, 7
    s_add_u32 s14, s13, s14
    v_add_u32 v60, s14, v60
    v_lshlrev_b32 v62, 15, v61
    s_lshr_b32 s14, s87, 4
    s_lshl_b32 s14, s14, 4
    s_add_u32 s13, s13, s14
    s_add_u32 s13, s13, 0x1000
    v_add_u32 v62, s13, v62
    v_and_b32 v63, 1, v1
    v_mul_u32_u24 v63, 0x0202, v63
    v_lshl_or_b32 v63, v63, 16, v63
    v_add_u32 v63, 0x01000100, v63
    s_mov_b32 s12, 200000
L_poll_t2:
    s_mov_b32 s13, 0
    buffer_load_dwordx4 v[16:19], v60, s[56:59], s13 offen sc1
    buffer_load_dwordx4 v[32:35], v62, s[56:59], s13 offen sc1
    s_add_u32 s13, s13, 8192
    buffer_load_dwordx4 v[20:23], v60, s[56:59], s13 offen sc1
    buffer_load_dwordx4 v[36:39], v62, s[56:59], s13 offen sc1
    s_add_u32 s13, s13, 8192
    buffer_load_dwordx4 v[24:27], v60, s[56:59], s13 offen sc1
    buffer_load_dwordx4 v[40:43], v62, s[56:59], s13 offen sc1
    s_add_u32 s13, s13, 8192
    buffer_load_dwordx4 v[28:31], v60, s[56:59], s13 offen sc1
    buffer_load_dwordx4 v[44:47], v62, s[56:59], s13 offen sc1
    s_waitcnt vmcnt(0)
    v_xor_b32 v17, s10, v17
    v_xor_b32 v19, s10, v19
    v_xor_b32 v21, s10, v21
    v_xor_b32 v23, s10, v23
    v_xor_b32 v25, s10, v25
    v_xor_b32 v27, s10, v27
    v_xor_b32 v29, s10, v29
    v_xor_b32 v31, s10, v31
    v_xor_b32 v33, s10, v33
    v_xor_b32 v35, s10, v35
    v_xor_b32 v37, s10, v37
    v_xor_b32 v39, s10, v39
    v_xor_b32 v41, s10, v41
    v_xor_b32 v43, s10, v43
    v_xor_b32 v45, s10, v45
    v_xor_b32 v47, s10, v47
    v_or3_b32 v17, v17, v19, v21
    v_or3_b32 v23, v23, v25, v27
    v_or3_b32 v29, v29, v31, v33
    v_or3_b32 v35, v35, v37, v39
    v_or3_b32 v41, v41, v43, v45
    v_or3_b32 v17, v17, v23, v29
    v_or3_b32 v35, v35, v41, v47
    v_or_b32 v17, v17, v35
    v_cmp_ne_u32 vcc, 0, v17
    s_cbranch_vccz L_done_t2
    s_mov_b64 exec, vcc
    s_sleep 2
    s_sub_u32 s12, s12, 1
    s_cmp_lg_u32 s12, 0
    s_cbranch_scc1 L_poll_t2
L_done_t2:
    s_mov_b64 exec, -1
    v_max3_f32 v52, v32, v36, v40
    v_max_f32 v52, v52, v44
    s_nop 1
    v_max_f32_dpp v52, v52, v52 row_ror:8 row_mask:0xf bank_mask:0xf
    v_mov_b32 v53, v52
    s_nop 1
    v_permlane32_swap_b32 v52, v53
    v_max_f32 v52, v52, v53
    v_mov_b32 v53, v52
    s_nop 1
    v_permlane16_swap_b32 v52, v53
    v_max_f32 v52, v52, v53
    v_sub_f32 v32, v32, v52
    v_sub_f32 v36, v36, v52
    v_sub_f32 v40, v40, v52
    v_sub_f32 v44, v44, v52
    v_exp_f32 v32, v32
    v_exp_f32 v36, v36
    v_exp_f32 v40, v40
    v_exp_f32 v44, v44
    v_mul_f32 v52, v32, v16
    v_mul_f32 v53, v32, v18
    v_mul_f32 v54, v32, v34
    v_fmac_f32 v52, v36, v20
    v_fmac_f32 v53, v36, v22
    v_fmac_f32 v54, v36, v38
    v_fmac_f32 v52, v40, v24
    v_fmac_f32 v53, v40, v26
    v_fmac_f32 v54, v40, v42
    v_fmac_f32 v52, v44, v28
    v_fmac_f32 v53, v44, v30
    v_fmac_f32 v54, v44, v46
    v_add_f32_dpp v52, v52, v52 row_ror:8 row_mask:0xf bank_mask:0xf
    v_add_f32_dpp v53, v53, v53 row_ror:8 row_mask:0xf bank_mask:0xf
    v_add_f32_dpp v54, v54, v54 row_ror:8 row_mask:0xf bank_mask:0xf
    v_mov_b32 v55, v52
    v_mov_b32 v56, v53
    v_mov_b32 v57, v54
    s_nop 1
    v_permlane32_swap_b32 v52, v55
    v_permlane32_swap_b32 v53, v56
    v_permlane32_swap_b32 v54, v57
    v_add_f32 v52, v52, v55
    v_add_f32 v53, v53, v56
    v_add_f32 v54, v54, v57
    v_mov_b32 v55, v52
    v_mov_b32 v56, v53
    v_mov_b32 v57, v54
    s_nop 1
    v_permlane16_swap_b32 v52, v55
    v_permlane16_swap_b32 v53, v56
    v_permlane16_swap_b32 v54, v57
    v_add_f32 v52, v52, v55
    v_add_f32 v53, v53, v56
    v_add_f32 v54, v54, v57
    v_rcp_f32 v54, v54
    s_nop 0
    v_mul_f32 v52, v52, v54
    v_mul_f32 v53, v53, v54
    v_cvt_pk_bf16_f32 v60, v52, v53
    v_lshrrev_b32 v62, 1, v1
    v_lshlrev_b32 v62, 2, v62
    v_add_u32 v61, 0, v62
    ds_bpermute_b32 v40, v61, v60
    v_add_u32 v61, 8, v62
    ds_bpermute_b32 v41, v61, v60
    v_add_u32 v61, 16, v62
    ds_bpermute_b32 v42, v61, v60
    v_add_u32 v61, 24, v62
    ds_bpermute_b32 v43, v61, v60
    s_waitcnt lgkmcnt(0)
    v_perm_b32 v40, v40, v40, v63
    v_perm_b32 v41, v41, v41, v63
    v_perm_b32 v42, v42, v42, v63
    v_perm_b32 v43, v43, v43, v63
    v_and_b32 v44, v40, v4
    v_and_b32 v45, v40, v5
    v_and_b32 v46, v40, v6
    v_and_b32 v47, v40, v7
    v_and_b32 v48, v41, v4
    v_and_b32 v49, v41, v5
    v_and_b32 v50, v41, v6
    v_and_b32 v51, v41, v7
    v_and_b32 v52, v42, v4
    v_and_b32 v53, v42, v5
    v_and_b32 v54, v42, v6
    v_and_b32 v55, v42, v7
    v_and_b32 v56, v43, v4
    v_and_b32 v57, v43, v5
    v_and_b32 v58, v43, v6
    v_and_b32 v59, v43, v7
    s_nop 1
    v_mfma_f32_16x16x32_bf16 v[8:11], v[44:47], v[64:67], 0
    v_mfma_f32_16x16x32_bf16 v[12:15], v[44:47], v[68:71], 0
    v_mfma_f32_16x16x32_bf16 v[16:19], v[44:47], v[72:75], 0
    v_mfma_f32_16x16x32_bf16 v[20:23], v[44:47], v[76:79], 0
    v_mfma_f32_16x16x32_bf16 v[8:11], v[48:51], v[80:83], v[8:11]
    v_mfma_f32_16x16x32_bf16 v[12:15], v[48:51], v[84:87], v[12:15]
    v_mfma_f32_16x16x32_bf16 v[16:19], v[48:51], v[88:91], v[16:19]
    v_mfma_f32_16x16x32_bf16 v[20:23], v[48:51], v[92:95], v[20:23]
    v_mfma_f32_16x16x32_bf16 v[8:11], v[52:55], v[96:99], v[8:11]
    v_mfma_f32_16x16x32_bf16 v[12:15], v[52:55], v[100:103], v[12:15]
    v_mfma_f32_16x16x32_bf16 v[16:19], v[52:55], v[104:107], v[16:19]
    v_mfma_f32_16x16x32_bf16 v[20:23], v[52:55], v[108:111], v[20:23]
    v_mfma_f32_16x16x32_bf16 v[8:11], v[56:59], v[112:115], v[8:11]
    v_mfma_f32_16x16x32_bf16 v[12:15], v[56:59], v[116:119], v[12:15]
    v_mfma_f32_16x16x32_bf16 v[16:19], v[56:59], v[120:123], v[16:19]
    v_mfma_f32_16x16x32_bf16 v[20:23], v[56:59], v[124:127], v[20:23]
    v_lshlrev_b32 v62, 6, v3
    v_lshl_add_u32 v62, v1, 5, v62
    s_lshl_b32 s13, s2, 12
    s_add_u32 s13, s13, 4194304
    v_add_u32 v62, s13, v62
    v_mov_b32 v25, s10
    v_mov_b32 v27, s10
    v_mov_b32 v29, s10
    v_mov_b32 v31, s10
    v_mov_b32 v33, s10
    v_mov_b32 v35, s10
    v_mov_b32 v37, s10
    v_mov_b32 v39, s10
    v_mov_b32 v41, s10
    v_mov_b32 v43, s10
    v_mov_b32 v45, s10
    v_mov_b32 v47, s10
    v_mov_b32 v49, s10
    v_mov_b32 v51, s10
    v_mov_b32 v53, s10
    v_mov_b32 v55, s10
    s_nop 3
    v_mov_b32 v24, v8
    v_mov_b32 v26, v9
    v_mov_b32 v28, v10
    v_mov_b32 v30, v11
    v_mov_b32 v32, v12
    v_mov_b32 v34, v13
    v_mov_b32 v36, v14
    v_mov_b32 v38, v15
    v_mov_b32 v40, v16
    v_mov_b32 v42, v17
    v_mov_b32 v44, v18
    v_mov_b32 v46, v19
    v_mov_b32 v48, v20
    v_mov_b32 v50, v21
    v_mov_b32 v52, v22
    v_mov_b32 v54, v23
    s_mov_b32 exec_hi, 0
    global_store_dwordx4 v62, v[24:27], s[42:43] offset:0 sc1
    global_store_dwordx4 v62, v[28:31], s[42:43] offset:16 sc1
    global_store_dwordx4 v62, v[32:35], s[42:43] offset:1024 sc1
    global_store_dwordx4 v62, v[36:39], s[42:43] offset:1040 sc1
    global_store_dwordx4 v62, v[40:43], s[42:43] offset:2048 sc1
    global_store_dwordx4 v62, v[44:47], s[42:43] offset:2064 sc1
    s_mov_b64 exec, 0x00ff00ff
    global_store_dwordx4 v62, v[48:51], s[42:43] offset:3072 sc1
    global_store_dwordx4 v62, v[52:55], s[42:43] offset:3088 sc1
    s_mov_b64 exec, -1
L_t3_check:
    s_cmp_lt_u32 s81, 28
    s_cbranch_scc1 L_end
    s_sub_u32 s6, s81, 28
    s_lshl_b32 s6, s6, 3
    s_add_u32 s6, s6, s80
    s_cmp_ge_u32 s6, 28
    s_cbranch_scc1 L_end
    v_lshrrev_b32 v60, 3, v0
    v_lshlrev_b32 v60, 12, v60
    v_and_b32 v61, 7, v0
    v_lshl_add_u32 v60, v61, 4, v60
    s_lshl_b32 s13, s6, 7
    v_add_u32 v60, s13, v60
    s_lshl_b32 s13, s6, 5
    v_lshlrev_b32 v61, 2, v61
    v_add_u32 v61, s13, v61
    global_load_dword v56, v61, s[34:35]
    s_mov_b32 s64, 4194304
    s_mov_b32 s65, 4718592
    s_mov_b32 s66, 5242880
    s_mov_b32 s67, 5767168
    s_cmp_ge_u32 s3, 12
    s_cbranch_scc1 L_t3_p3
    s_mov_b32 s12, 200000
L_poll_t3b2:
    buffer_load_dwordx4 v[24:27], v60, s[56:59], s66 offen sc1
    buffer_load_dwordx4 v[28:31], v60, s[56:59], s67 offen sc1
    s_waitcnt vmcnt(0)
    v_xor_b32 v25, s10, v25
    v_xor_b32 v27, s10, v27
    v_xor_b32 v29, s10, v29
    v_xor_b32 v31, s10, v31
    v_or3_b32 v25, v25, v27, v29
    v_or_b32 v25, v25, v31
    v_cmp_ne_u32 vcc, 0, v25
    s_cbranch_vccz L_done_t3b2
    s_mov_b64 exec, vcc
    s_sleep 2
    s_sub_u32 s12, s12, 1
    s_cmp_lg_u32 s12, 0
    s_cbranch_scc1 L_poll_t3b2
L_done_t3b2:
    s_mov_b64 exec, -1
    s_branch L_t3_pa
L_t3_p3:
    v_mov_b32 v28, 0
    v_mov_b32 v30, 0
    s_mov_b32 s12, 200000
L_poll_t3b1:
    buffer_load_dwordx4 v[24:27], v60, s[56:59], s66 offen sc1
    s_waitcnt vmcnt(0)
    v_xor_b32 v25, s10, v25
    v_xor_b32 v27, s10, v27
    v_or_b32 v25, v25, v27
    v_cmp_ne_u32 vcc, 0, v25
    s_cbranch_vccz L_done_t3b1
    s_mov_b64 exec, vcc
    s_sleep 2
    s_sub_u32 s12, s12, 1
    s_cmp_lg_u32 s12, 0
    s_cbranch_scc1 L_poll_t3b1
L_done_t3b1:
    s_mov_b64 exec, -1
L_t3_pa:
    v_add_f32 v42, v24, v28
    v_add_f32 v43, v26, v30
    s_nop 0
    v_add_f32_dpp v42, v42, v42 row_ror:8 row_mask:0xf bank_mask:0xf
    v_add_f32_dpp v43, v43, v43 row_ror:8 row_mask:0xf bank_mask:0xf
    v_mov_b32 v44, v42
    v_mov_b32 v45, v43
    s_nop 1
    v_permlane32_swap_b32 v42, v44
    v_permlane32_swap_b32 v43, v45
    v_add_f32 v42, v42, v44
    v_add_f32 v43, v43, v45
    v_mov_b32 v44, v42
    v_mov_b32 v45, v43
    s_nop 1
    v_permlane16_swap_b32 v42, v44
    v_permlane16_swap_b32 v43, v45
    v_add_f32 v42, v42, v44
    v_add_f32 v43, v43, v45
    v_lshlrev_b32 v62, 3, v2
    s_lshl_b32 s13, s3, 6
    v_add_u32 v62, s13, v62
    s_mov_b64 exec, 0xff
    ds_write_b64 v62, v[42:43] offset:2688
    s_mov_b64 exec, -1
    s_waitcnt lgkmcnt(0)
    s_barrier
    s_cmp_lg_u32 s3, 0
    s_cbranch_scc1 L_t3_a
    v_lshlrev_b32 v63, 3, v2
    ds_read_b64 v[42:43], v63 offset:2688
    ds_read_b64 v[44:45], v63 offset:3200
    v_mov_b32 v59, 0
    ds_read_b32 v57, v59 offset:2096
    s_waitcnt lgkmcnt(0)
    v_add_f32 v42, v42, v44
    v_add_f32 v43, v43, v45
    s_nop 0
    v_add_f32_dpp v42, v42, v42 row_ror:8 row_mask:0xf bank_mask:0xf
    v_add_f32_dpp v43, v43, v43 row_ror:8 row_mask:0xf bank_mask:0xf
    v_mov_b32 v44, v42
    v_mov_b32 v45, v43
    s_nop 1
    v_permlane32_swap_b32 v42, v44
    v_permlane32_swap_b32 v43, v45
    v_add_f32 v42, v42, v44
    v_add_f32 v43, v43, v45
    v_mov_b32 v44, v42
    v_mov_b32 v45, v43
    s_nop 1
    v_permlane16_swap_b32 v42, v44
    v_permlane16_swap_b32 v43, v45
    v_add_f32 v42, v42, v44
    v_add_f32 v43, v43, v45
    v_cvt_pk_bf16_f32 v42, v42, v43
    v_lshlrev_b32 v44, 16, v42
    v_and_b32 v45, 0xffff0000, v42
    v_lshlrev_b32 v46, 16, v56
    v_and_b32 v47, 0xffff0000, v56
    v_add_f32 v44, v44, v46
    v_add_f32 v45, v45, v47
    v_cvt_pk_bf16_f32 v42, v44, v45
    v_sub_f32 v58, 1.0, v57
    v_cvt_pk_bf16_f32 v58, v58, v58
    v_lshlrev_b32 v58, 16, v58
    v_lshlrev_b32 v46, 16, v42
    v_and_b32 v47, 0xffff0000, v42
    v_mul_f32 v46, v46, v58
    v_mul_f32 v47, v47, v58
    v_cvt_pk_bf16_f32 v42, v46, v47
    v_lshlrev_b32 v50, 16, v42
    v_and_b32 v51, 0xffff0000, v42
L_t3_a:
    s_mov_b32 s12, 200000
L_poll_t3a:
    buffer_load_dwordx4 v[16:19], v60, s[56:59], s64 offen sc1
    buffer_load_dwordx4 v[20:23], v60, s[56:59], s65 offen sc1
    s_waitcnt vmcnt(0)
    v_xor_b32 v17, s10, v17
    v_xor_b32 v19, s10, v19
    v_xor_b32 v21, s10, v21
    v_xor_b32 v23, s10, v23
    v_or3_b32 v17, v17, v19, v21
    v_or_b32 v17, v17, v23
    v_cmp_ne_u32 vcc, 0, v17
    s_cbranch_vccz L_done_t3a
    s_mov_b64 exec, vcc
    s_sleep 2
    s_sub_u32 s12, s12, 1
    s_cmp_lg_u32 s12, 0
    s_cbranch_scc1 L_poll_t3a
L_done_t3a:
    s_mov_b64 exec, -1
    v_add_f32 v40, v16, v20
    v_add_f32 v41, v18, v22
    s_nop 0
    v_add_f32_dpp v40, v40, v40 row_ror:8 row_mask:0xf bank_mask:0xf
    v_add_f32_dpp v41, v41, v41 row_ror:8 row_mask:0xf bank_mask:0xf
    v_mov_b32 v44, v40
    v_mov_b32 v45, v41
    s_nop 1
    v_permlane32_swap_b32 v40, v44
    v_permlane32_swap_b32 v41, v45
    v_add_f32 v40, v40, v44
    v_add_f32 v41, v41, v45
    v_mov_b32 v44, v40
    v_mov_b32 v45, v41
    s_nop 1
    v_permlane16_swap_b32 v40, v44
    v_permlane16_swap_b32 v41, v45
    v_add_f32 v40, v40, v44
    v_add_f32 v41, v41, v45
    s_mov_b64 exec, 0xff
    ds_write_b64 v62, v[40:41] offset:3712
    s_mov_b64 exec, -1
    s_waitcnt lgkmcnt(0)
    s_barrier
    s_cmp_lg_u32 s3, 0
    s_cbranch_scc1 L_end
    ds_read_b64 v[40:41], v63 offset:3712
    ds_read_b64 v[44:45], v63 offset:4224
    s_waitcnt lgkmcnt(0)
    v_add_f32 v40, v40, v44
    v_add_f32 v41, v41, v45
    s_nop 0
    v_add_f32_dpp v40, v40, v40 row_ror:8 row_mask:0xf bank_mask:0xf
    v_add_f32_dpp v41, v41, v41 row_ror:8 row_mask:0xf bank_mask:0xf
    v_mov_b32 v44, v40
    v_mov_b32 v45, v41
    s_nop 1
    v_permlane32_swap_b32 v40, v44
    v_permlane32_swap_b32 v41, v45
    v_add_f32 v40, v40, v44
    v_add_f32 v41, v41, v45
    v_mov_b32 v44, v40
    v_mov_b32 v45, v41
    s_nop 1
    v_permlane16_swap_b32 v40, v44
    v_permlane16_swap_b32 v41, v45
    v_add_f32 v40, v40, v44
    v_add_f32 v41, v41, v45
    v_cvt_pk_bf16_f32 v40, v40, v41
    v_lshlrev_b32 v44, 16, v40
    v_and_b32 v45, 0xffff0000, v40
    v_mul_f32 v44, v44, v57
    v_mul_f32 v45, v45, v57
    v_cvt_pk_bf16_f32 v40, v44, v45
    v_lshlrev_b32 v44, 16, v40
    v_and_b32 v45, 0xffff0000, v40
    v_add_f32 v44, v44, v50
    v_add_f32 v45, v45, v51
    v_cvt_pk_bf16_f32 v40, v44, v45
    s_mov_b64 exec, 0xff
    global_store_dword v61, v40, s[38:39] sc0 sc1
    s_cmp_lg_u32 s6, 0
    s_cbranch_scc1 L_noepoch
    s_add_u32 s15, s15, 1
    v_mov_b32 v44, s15
    v_mov_b32 v45, 7936
    s_mov_b64 exec, 1
    global_store_dword v45, v44, s[42:43] sc1
L_noepoch:
    s_mov_b64 exec, -1
L_end:
    s_endpgm
.section .rodata,"a"
.p2align 6
.amdhsa_kernel gated_mix__gqa_block_cached__dense_activation_gelu__decode_kernel
  .amdhsa_next_free_vgpr 128
  .amdhsa_next_free_sgpr 96
  .amdhsa_accum_offset 128
  .amdhsa_group_segment_fixed_size 0
  .amdhsa_kernarg_size 112
  .amdhsa_user_sgpr_count 2
  .amdhsa_user_sgpr_kernarg_segment_ptr 1
  .amdhsa_system_sgpr_workgroup_id_x 1
.end_amdhsa_kernel
```
